```python
import torch

def _softmax(x, axis=-1):
    return torch.softmax(x, dim=axis)

def _gelu(x):
    return torch.nn.functional.gelu(x, approximate='tanh')

def _silu(x):
    return torch.nn.functional.silu(x)

def _sigmoid(x):
    return torch.sigmoid(x)

def _layernorm(x, axis=-1, eps=1e-05):
    m = x.mean(dim=axis, keepdim=True)
    v = x.var(dim=axis, keepdim=True, unbiased=False)
    return (x - m) / torch.sqrt(v + eps)

def _scatter_add(tgt, idx, src, axis=0):
    return tgt.clone().index_add_(axis, idx, src)

def _segment_sum(src, seg, n):
    out = torch.zeros((n,) + src.shape[1:], dtype=src.dtype)
    return out.index_add_(0, seg, src)

def _pad(x, pw):
    flat = tuple((v for pair in reversed(pw) for v in pair))
    return torch.nn.functional.pad(x, flat)
kernel_name = 'adaLN_cond__ssm_conv_s4__geglu_ffn__prompt'

def setup_inputs():

    _w = lambda a: (lambda t: t.to(torch.bfloat16) if t.is_floating_point() else t)(torch.as_tensor(a))

    def _A_setup():
        B, L, D, N = (1, 2048, 512, 128)
        A_re = -(lambda _x: torch.exp(torch.as_tensor(_x)))((lambda *s: torch.randn(*s, dtype=torch.bfloat16) * 3.2)(D, N))
        A_im = torch.pi * (lambda *s: torch.randn(*s, dtype=torch.bfloat16) * 0.1)(D, N)
        B_re = (lambda *s: torch.randn(*s, dtype=torch.bfloat16) * 0.2)(D, N)
        B_im = (lambda *s: torch.randn(*s, dtype=torch.bfloat16) * 0.2)(D, N)
        C_re = (lambda *s: torch.randn(*s, dtype=torch.bfloat16) * 0.2)(D, N)
        C_im = (lambda *s: torch.randn(*s, dtype=torch.bfloat16) * 0.2)(D, N)
        log_dt = (lambda *s: torch.randn(*s, dtype=torch.bfloat16) * 0.1)(D) * 0.5 - 4.0
        Dskip = (lambda *s: torch.randn(*s, dtype=torch.bfloat16) * 0.1)(D)
        return {'u': _w((lambda *s: torch.randn(*s, dtype=torch.bfloat16) * 0.05)(B, L, D)), 'A_re': _w(A_re), 'A_im': _w(A_im), 'B_re': _w(B_re), 'B_im': _w(B_im), 'C_re': _w(C_re), 'C_im': _w(C_im), 'log_dt': _w(log_dt), 'Dskip': _w(Dskip)}
    _A_in = _A_setup()

    def _B_setup():
        B, S, D, F = (1, 2048, 512, 1792)
        return {'x': _w((lambda *s: torch.randn(*s, dtype=torch.bfloat16) * 0.05)(B, S, D)), 'w_gate': _w((lambda *s: torch.randn(*s, dtype=torch.bfloat16) * 0.05)(D, F)), 'w_up': _w((lambda *s: torch.randn(*s, dtype=torch.bfloat16) * 0.05)(D, F)), 'w_down': _w((lambda *s: torch.randn(*s, dtype=torch.bfloat16) * 0.05)(F, D))}
    _B_in = _B_setup()
    return {'A_u': _A_in['u'], 'A_A_re': _A_in['A_re'], 'A_A_im': _A_in['A_im'], 'A_B_re': _A_in['B_re'], 'A_B_im': _A_in['B_im'], 'A_C_re': _A_in['C_re'], 'A_C_im': _A_in['C_im'], 'A_log_dt': _A_in['log_dt'], 'A_Dskip': _A_in['Dskip'], 'B_x': _B_in['x'], 'B_w_gate': _B_in['w_gate'], 'B_w_up': _B_in['w_up'], 'B_w_down': _B_in['w_down'], 'c': _w((lambda *s: torch.randn(*s, dtype=torch.bfloat16) * 0.1)(1, 512) * 8.0), 'w_mod': _w((lambda *s: torch.randn(*s, dtype=torch.bfloat16) * 0.1)(512, 6 * 512) * 512 ** (-0.5) * 8.0)}

def reference(A_u, A_A_re, A_A_im, A_B_re, A_B_im, A_C_re, A_C_im, A_log_dt, A_Dskip, B_x, B_w_gate, B_w_up, B_w_down, c, w_mod):

    def _A_ref(u, A_re, A_im, B_re, B_im, C_re, C_im, log_dt, Dskip):
        Bsz, L, D = u.shape
        dt = torch.exp(log_dt)[:, None]
        A = A_re + 1j * A_im
        Bc = B_re + 1j * B_im
        Cc = C_re + 1j * C_im
        logdA = dt * A
        dB = dt * Bc
        l = (lambda x, dt: x.to(dt))(torch.arange(L), A_re.dtype)
        P = torch.exp(logdA[:, :, None] * l[None, None, :])
        K = torch.einsum('dn,dnl,dn->dl', Cc, P, dB).real
        L2 = 2 * L
        Kp = _pad(K, ((0, 0), (0, L)))
        up = (lambda x, *d: x.permute(*d))(u, 0, 2, 1)
        up = _pad(up, ((0, 0), (0, 0), (0, L)))
        Kf = (lambda x, axes=(-2, -1): torch.fft.rfft2(x.float(), dim=axes))(Kp[:, None, :], axes=(-2, -1))
        Uf = (lambda x, axes=(-2, -1): torch.fft.rfft2(x.float(), dim=axes))(up[:, :, None, :], axes=(-2, -1))
        Yf = Uf * Kf[None, :, :, :]
        y = (lambda x, s, axes=(-2, -1): torch.fft.irfft2(x, s=s, dim=axes).to(torch.bfloat16))(Yf, (1, L2), axes=(-2, -1))[:, :, 0, :L]
        y = (lambda x, *d: x.permute(*d))(y, 0, 2, 1) + u * Dskip[None, None, :]
        return y

    def _B_ref(x, w_gate, w_up, w_down):
        return _gelu(x @ w_gate) * (x @ w_up) @ w_down
    x = A_u
    mod = (_silu(c) @ w_mod).reshape(c.shape[0], 6, 1, -1)
    sa, ca, ga, sb, cb, gb = (mod[:, 0].clone(), mod[:, 1].clone(), mod[:, 2].clone(), mod[:, 3].clone(), mod[:, 4].clone(), mod[:, 5].clone())
    h = _layernorm(x, axis=-1) * (1 + ca) + sa
    x = x + ga * _A_ref(h, A_A_re, A_A_im, A_B_re, A_B_im, A_C_re, A_C_im, A_log_dt, A_Dskip)
    h = _layernorm(x, axis=-1) * (1 + cb) + sb
    x = x + gb * _B_ref(h, B_w_gate, B_w_up, B_w_down)
    return x
```

```asm
; @launch grid=(256,1,1) block=(256,1,1) lds=163840
.amdgcn_target "amdgcn-amd-amdhsa--gfx950"
.text
.globl adaLN_cond__ssm_conv_s4__geglu_ffn__prompt_kernel
.p2align 8
.type adaLN_cond__ssm_conv_s4__geglu_ffn__prompt_kernel,@function
adaLN_cond__ssm_conv_s4__geglu_ffn__prompt_kernel:
  s_load_dwordx16 s[4:19], s[0:1], 0
  s_load_dwordx16 s[20:35], s[0:1], 64
  s_load_dwordx4 s[36:39], s[0:1], 128
  s_cmp_ge_u32 s2, 256
  s_cbranch_scc1 L_end
  v_lshrrev_b32 v68, 6, v0
  v_and_b32 v69, 63, v0
  v_readfirstlane_b32 s45, v68
  s_lshr_b32 s3, s2, 3
  s_getpc_b64 s[68:69]
L_pc:
  s_lshl2_add_u32 s58, s3, s45
  s_lshl_b32 s70, s58, 8
  s_min_u32 s70, s70, L_end-L_pc-256
  v_lshl_add_u32 v75, v69, 2, s70
  global_load_dword v123, v75, s[68:69]
  s_add_u32 s72, s68, L_tab-L_pc+4096
  s_addc_u32 s73, s69, 0
  v_lshlrev_b32 v97, 4, v0
  global_load_dwordx4 v[160:163], v97, s[72:73] offset:-4096
  global_load_dwordx4 v[164:167], v97, s[72:73]
  v_add_u32 v97, 8192, v97
  global_load_dwordx4 v[152:155], v97, s[72:73] offset:-4096
  global_load_dwordx4 v[64:67], v97, s[72:73]
  s_and_b32 s59, s2, 7
  s_lshl_b32 s44, s59, 5
  s_or_b32 s44, s44, s3
  v_lshlrev_b32 v1, 4, v69
  v_and_b32 v70, 3, v0
  v_and_b32 v71, 0xfc, v0
  s_lshl_b32 s61, s44, 13
  v_lshl_add_u32 v71, v71, 2, s61
  v_lshl_add_u32 v3, v70, 11, v71
  v_lshrrev_b32 v72, 3, v69
  v_min_u32 v72, 5, v72
  v_and_b32 v73, 0x70, v1
  v_lshl_add_u32 v72, v72, 10, v73
  s_lshl_b32 s60, s58, 3
  s_mul_i32 s58, s58, 24576
  s_lshl_b32 s59, s59, 7
  s_add_u32 s58, s58, s59
  s_add_u32 s58, s58, 3072
  v_add_u32 v72, s58, v72
  v_add_u32 v73, 12288, v72
  s_lshl_b32 s58, s44, 9
  v_lshl_add_u32 v74, v0, 1, s58
  s_lshl_b32 s61, s44, 2
  v_mov_b32 v28, 0
  v_mov_b32 v29, 0
  v_mov_b32 v30, 0
  v_mov_b32 v31, 0
  v_mov_b32 v32, 0
  v_mov_b32 v33, 0
  v_mov_b32 v2, 0
  s_waitcnt lgkmcnt(0)
  s_load_dwordx2 s[62:63], s[30:31], s60
  s_load_dword s64, s[18:19], s61
  global_load_dwordx4 v[4:7], v3, s[4:5]
  global_load_dwordx4 v[8:11], v3, s[4:5] offset:1024
  s_load_dword s81, s[20:21], s61
  global_load_dword v2, v2, s[38:39] sc1
  global_load_short_d16_hi v28, v74, s[6:7]
  global_load_short_d16_hi v29, v74, s[8:9]
  global_load_short_d16_hi v30, v74, s[10:11]
  global_load_short_d16_hi v31, v74, s[12:13]
  global_load_short_d16_hi v32, v74, s[14:15]
  global_load_short_d16_hi v33, v74, s[16:17]
  s_mov_b32 s47, 0xffff0000
  s_mov_b32 s49, 0x05040100
  s_mov_b32 s50, 0x07060302
  s_mov_b32 s51, 0x3f803f80
  v_mov_b32 v80, 0xbfb8aa3b
  s_add_u32 s65, s61, s45
  s_min_u32 s58, s65, 895
  v_and_b32 v76, 15, v69
  s_lshl_b32 s37, s58, 11
  s_mov_b64 s[0:1], s[28:29]
  s_bitcmp1_b32 s58, 0
  s_cselect_b32 s26, s26, s24
  s_cselect_b32 s27, s27, s25
  s_cselect_b32 s14, 256, 0
  s_bfe_u32 s59, s58, 0x40001
  s_lshr_b32 s60, s58, 5
  s_mul_i32 s66, s59, 114688
  s_lshl_b32 s61, s60, 7
  s_add_u32 s66, s66, s61
  v_lshrrev_b32 v75, 4, v69
  v_mul_u32_u24 v75, 28672, v75
  v_lshl_add_u32 v78, v76, 3, s66
  v_add_u32 v35, v78, v75
  s_lshl_b32 s24, s65, 7
  s_add_u32 s24, s24, 786432
  v_mov_b32 v92, 0
  v_mov_b32 v93, 0
  v_mov_b32 v94, 0
  v_mov_b32 v95, 0
  v_lshlrev_b32_e64 v96, 4, v0
  v_add_u32 v96, 140288, v96
  s_lshr_b32 s17, s45, 1
  s_mul_i32 s58, s17, 4096
  s_add_u32 s58, s58, 131072
  v_lshl_add_u32 v77, v0, 2, s58
  s_mov_b32 s67, 98304
  ds_write_b128 v96, v[92:95]
  ds_write_b128 v96, v[92:95] offset:4096
  ds_write_b128 v96, v[92:95] offset:8192
  ds_write_b32 v77, v92
  s_mov_b32 s40, s38
  s_mov_b32 s41, s39
  s_mov_b32 s42, 268435456
  s_mov_b32 s43, 0x20000
  s_mov_b32 s48, 400000
  v_mov_b32 v52, 0x3b000000
  v_mov_b32 v53, 0x3727c5ac
  s_mul_i32 s58, s44, 8448
  s_lshl_b32 s59, s45, 11
  s_add_u32 s59, s58, s59
  s_add_u32 s59, s59, 1441792
  s_lshl_b32 s60, s65, 9
  s_add_u32 s60, s60, 917504
  s_mov_b32 s46, 1664525
  s_lshl_b32 s61, s45, 10
  s_add_u32 s58, s58, s61
  s_add_u32 s10, s58, 3670016
  s_add_u32 s11, s58, 3674112
  s_lshl_b32 s13, s44, 4
  s_add_u32 s13, s13, 32768
  s_cmp_eq_u32 s45, 0
  s_cselect_b32 s12, s13, 268435456
  s_mov_b32 s25, 1879076864
  v_lshlrev_b32 v252, 2, v70
  v_add_u32 v253, 2, v252
  global_load_dwordx4 v[12:15], v72, s[32:33] offset:-3072
  global_load_dwordx4 v[16:19], v72, s[32:33] offset:3072
  global_load_dwordx4 v[20:23], v73, s[32:33] offset:-3072
  global_load_dwordx4 v[24:27], v73, s[32:33] offset:3072
  v_and_b32 v157, 7, v0
  v_lshl_add_u32 v156, v157, 7, s11
  s_sub_u32 s58, s24, 524288
  v_cmp_gt_u32 vcc, 2, v157
  v_lshl_add_u32 v157, v157, 19, s58
  v_mov_b32 v158, s13
  v_cndmask_b32 v158, v158, v157, vcc
  v_cmp_gt_u32 vcc, 128, v1
  s_nop 1
  v_cndmask_b32 v158, v158, v156, vcc
  s_waitcnt vmcnt(13)
  v_add_u32_sdwa v112, s67, v160 dst_sel:DWORD dst_unused:UNUSED_PAD src0_sel:DWORD src1_sel:WORD_0
  v_add_u32_sdwa v113, s67, v160 dst_sel:DWORD dst_unused:UNUSED_PAD src0_sel:DWORD src1_sel:WORD_1
  v_add_u32_sdwa v114, s67, v161 dst_sel:DWORD dst_unused:UNUSED_PAD src0_sel:DWORD src1_sel:WORD_0
  v_add_u32_sdwa v159, s67, v161 dst_sel:DWORD dst_unused:UNUSED_PAD src0_sel:DWORD src1_sel:WORD_1
  v_add_u32_sdwa v116, 0, v162 dst_sel:DWORD dst_unused:UNUSED_PAD src0_sel:DWORD src1_sel:WORD_0
  v_add_u32_sdwa v117, 0, v162 dst_sel:DWORD dst_unused:UNUSED_PAD src0_sel:DWORD src1_sel:WORD_1
  v_add_u32_sdwa v118, 0, v163 dst_sel:DWORD dst_unused:UNUSED_PAD src0_sel:DWORD src1_sel:WORD_0
  v_add_u32_sdwa v119, 0, v163 dst_sel:DWORD dst_unused:UNUSED_PAD src0_sel:DWORD src1_sel:WORD_1
  v_add_u32_sdwa v127, 0, v164 dst_sel:DWORD dst_unused:UNUSED_PAD src0_sel:DWORD src1_sel:WORD_0
  v_add_u32_sdwa v115, 0, v164 dst_sel:DWORD dst_unused:UNUSED_PAD src0_sel:DWORD src1_sel:WORD_1
  v_add_u32_sdwa v124, 0, v165 dst_sel:DWORD dst_unused:UNUSED_PAD src0_sel:DWORD src1_sel:WORD_0
  v_add_u32_sdwa v120, s67, v165 dst_sel:DWORD dst_unused:UNUSED_PAD src0_sel:DWORD src1_sel:WORD_1
  v_add_u32_sdwa v121, s67, v166 dst_sel:DWORD dst_unused:UNUSED_PAD src0_sel:DWORD src1_sel:WORD_0
  v_add_u32_sdwa v122, s67, v166 dst_sel:DWORD dst_unused:UNUSED_PAD src0_sel:DWORD src1_sel:WORD_1
  v_add_u32_sdwa v123, s67, v167 dst_sel:DWORD dst_unused:UNUSED_PAD src0_sel:DWORD src1_sel:WORD_0
  v_add_u32_sdwa v63, s67, v167 dst_sel:DWORD dst_unused:UNUSED_PAD src0_sel:DWORD src1_sel:WORD_1
  s_waitcnt lgkmcnt(0)
  s_lshl_b32 s74, s62, 16
  s_and_b32 s75, s62, s47
  s_lshl_b32 s76, s63, 16
  s_and_b32 s77, s63, s47
  v_mul_f32 v81, s74, v80
  v_mul_f32 v82, s75, v80
  v_mul_f32 v83, s76, v80
  v_mul_f32 v84, s77, v80
  s_lshl_b32 s62, s17, 4
  s_lshr_b32 s63, s64, s62
  s_lshl_b32 s63, s63, 16
  v_exp_f32 v81, v81
  v_exp_f32 v82, v82
  v_exp_f32 v83, v83
  v_exp_f32 v84, v84
  v_mul_f32 v34, s63, -v80
  v_add_f32 v81, 1.0, v81
  v_add_f32 v82, 1.0, v82
  v_add_f32 v83, 1.0, v83
  v_add_f32 v84, 1.0, v84
  v_exp_f32 v34, v34
  v_rcp_f32 v81, v81
  v_rcp_f32 v82, v82
  v_rcp_f32 v83, v83
  v_rcp_f32 v84, v84
  v_cvt_pk_bf16_f32 v34, v34, v34
  v_mul_f32 v81, s74, v81
  v_mul_f32 v82, s75, v82
  v_mul_f32 v83, s76, v83
  v_mul_f32 v84, s77, v84
  v_lshlrev_b32 v34, 16, v34
  v_cvt_pk_bf16_f32 v54, v81, v82
  v_cvt_pk_bf16_f32 v55, v83, v84
  s_lshr_b32 s80, s81, s62
  s_lshl_b32 s80, s80, 16
  s_waitcnt vmcnt(11)
  s_nop 0
  global_load_dwordx2 v[36:37], v35, s[26:27] offset:0
  global_load_dwordx2 v[38:39], v35, s[26:27] offset:3584
  v_add_u32 v35, 7168, v35
  global_load_dwordx2 v[40:41], v35, s[26:27] offset:0
  global_load_dwordx2 v[42:43], v35, s[26:27] offset:3584
  v_add_u32 v35, 7168, v35
  global_load_dwordx2 v[44:45], v35, s[26:27] offset:0
  global_load_dwordx2 v[46:47], v35, s[26:27] offset:3584
  v_add_u32 v35, 7168, v35
  global_load_dwordx2 v[48:49], v35, s[26:27] offset:0
  global_load_dwordx2 v[50:51], v35, s[26:27] offset:3584
  v_dot2_f32_bf16 v192, v4, s51, 0
  v_dot2_f32_bf16 v193, v8, s51, 0
  v_dot2_f32_bf16 v194, v4, v4, 0
  v_dot2_f32_bf16 v195, v8, v8, 0
  v_dot2_f32_bf16 v192, v5, s51, v192
  v_dot2_f32_bf16 v193, v9, s51, v193
  v_dot2_f32_bf16 v194, v5, v5, v194
  v_dot2_f32_bf16 v195, v9, v9, v195
  v_dot2_f32_bf16 v192, v6, s51, v192
  v_dot2_f32_bf16 v193, v10, s51, v193
  v_dot2_f32_bf16 v194, v6, v6, v194
  v_dot2_f32_bf16 v195, v10, v10, v195
  v_dot2_f32_bf16 v192, v7, s51, v192
  v_dot2_f32_bf16 v193, v11, s51, v193
  v_dot2_f32_bf16 v194, v7, v7, v194
  v_dot2_f32_bf16 v195, v11, v11, v195
  v_lshlrev_b32 v128, 16, v4
  v_and_b32 v129, s47, v4
  v_permlane32_swap_b32 v192, v193
  v_permlane32_swap_b32 v194, v195
  v_add_f32 v192, v192, v193
  v_add_f32 v194, v194, v195
  v_lshlrev_b32 v130, 16, v5
  v_and_b32 v131, s47, v5
  v_permlane16_swap_b32 v192, v194
  v_add_f32 v192, v192, v194
  v_lshlrev_b32 v132, 16, v6
  v_and_b32 v133, s47, v6
  v_add_f32_dpp v192, v192, v192 row_ror:4 row_mask:0xf bank_mask:0xf
  v_lshlrev_b32 v134, 16, v7
  v_and_b32 v135, s47, v7
  v_add_f32_dpp v192, v192, v192 row_ror:8 row_mask:0xf bank_mask:0xf
  ds_write_b32 v112, v192
  v_add_u32 v193, 20992, v63
  ds_write_b32 v193, v66
  s_waitcnt vmcnt(18) lgkmcnt(1)
  s_barrier
  ds_read_b128 v[196:199], v113 offset:0
  ds_read_b128 v[200:203], v113 offset:16
  ds_read_b128 v[204:207], v113 offset:32
  ds_read_b128 v[208:211], v113 offset:48
  v_lshlrev_b32 v136, 16, v8
  v_and_b32 v137, s47, v8
  v_lshlrev_b32 v138, 16, v9
  v_and_b32 v139, s47, v9
  v_lshlrev_b32 v140, 16, v10
  v_and_b32 v141, s47, v10
  v_lshlrev_b32 v142, 16, v11
  v_and_b32 v143, s47, v11
  v_mul_lo_u32 v192, v2, s46
  s_mov_b32 s46, 0x15554000
  v_add_u32 v192, 1013904223, v192
  v_bitop3_b32 v2, v192, v2, s46 bitop3:0x72
  v_alignbit_b32 v252, v2, v2, v252
  v_alignbit_b32 v253, v2, v2, v253
  v_and_b32 v252, s25, v252
  v_and_b32_e64 v253, s25, v253
  s_waitcnt lgkmcnt(0)
  v_pk_add_f32 v[196:197], v[196:197], v[200:201]
  v_pk_add_f32 v[198:199], v[198:199], v[202:203]
  v_pk_add_f32 v[204:205], v[204:205], v[208:209]
  v_pk_add_f32 v[206:207], v[206:207], v[210:211]
  v_pk_add_f32 v[196:197], v[196:197], v[204:205]
  v_pk_add_f32 v[198:199], v[198:199], v[206:207]
  v_pk_mul_f32 v[200:201], v[196:197], v[52:53] op_sel_hi:[1,0]
  v_pk_mul_f32 v[202:203], v[198:199], v[52:53] op_sel_hi:[1,0]
  v_fma_f32 v201, -v200, v200, v201
  v_fma_f32 v203, -v202, v202, v203
  v_max_f32 v201, 0, v201
  v_max_f32 v203, 0, v203
  v_add_f32 v201, v53, v201
  v_add_f32 v203, v53, v203
  v_rsq_f32 v196, v201
  v_rsq_f32 v198, v203
  v_mul_f32 v196, 0x0d800000, v196
  v_mul_f32 v198, 0x0d800000, v198
  v_mul_f32 v197, -v200, v196
  v_mul_f32 v199, -v202, v198
  v_pk_fma_f32 v[128:129], v[128:129], v[196:197], v[196:197] op_sel:[0,0,1] op_sel_hi:[1,0,1]
  v_pk_fma_f32 v[136:137], v[136:137], v[198:199], v[198:199] op_sel:[0,0,1] op_sel_hi:[1,0,1]
  v_cvt_pk_bf16_f32 v144, v128, v129
  v_cvt_pk_bf16_f32 v145, v136, v137
  v_bfi_b32 v144, s25, v252, v144
  v_bfi_b32 v145, s25, v253, v145
  v_pk_fma_f32 v[130:131], v[130:131], v[196:197], v[196:197] op_sel:[0,0,1] op_sel_hi:[1,0,1]
  v_pk_fma_f32 v[138:139], v[138:139], v[198:199], v[198:199] op_sel:[0,0,1] op_sel_hi:[1,0,1]
  v_cvt_pk_bf16_f32 v146, v130, v131
  v_cvt_pk_bf16_f32 v147, v138, v139
  v_bfi_b32 v146, s25, v252, v146
  v_bfi_b32 v147, s25, v253, v147
  buffer_store_dwordx4 v[144:147], v1, s[40:43], s59 offen offset:0 sc1
  v_pk_fma_f32 v[132:133], v[132:133], v[196:197], v[196:197] op_sel:[0,0,1] op_sel_hi:[1,0,1]
  v_pk_fma_f32 v[140:141], v[140:141], v[198:199], v[198:199] op_sel:[0,0,1] op_sel_hi:[1,0,1]
  v_cvt_pk_bf16_f32 v148, v132, v133
  v_cvt_pk_bf16_f32 v149, v140, v141
  v_bfi_b32 v148, s25, v252, v148
  v_bfi_b32 v149, s25, v253, v149
  v_pk_fma_f32 v[134:135], v[134:135], v[196:197], v[196:197] op_sel:[0,0,1] op_sel_hi:[1,0,1]
  v_pk_fma_f32 v[142:143], v[142:143], v[198:199], v[198:199] op_sel:[0,0,1] op_sel_hi:[1,0,1]
  v_cvt_pk_bf16_f32 v150, v134, v135
  v_cvt_pk_bf16_f32 v151, v142, v143
  v_bfi_b32 v150, s25, v252, v150
  v_bfi_b32 v151, s25, v253, v151
  buffer_store_dwordx4 v[148:151], v1, s[40:43], s59 offen offset:1024 sc1
  s_waitcnt vmcnt(14)
  v_mul_f32 v68, v34, v28
  v_mul_f32 v69, v34, v29
  v_mul_f32 v30, v34, v30
  v_mul_f32 v31, v34, v31
  v_mul_f32 v78, 0x3fb8aa3b, v68
  v_mul_f32 v79, 0.15915494, v69
  v_mul_f32 v76, v32, v30
  v_mul_f32 v77, v32, v31
  v_mul_f32 v81, 0x41000000, v78
  v_mul_f32 v82, 0x41000000, v79
  v_mul_f32 v84, 0x43800000, v78
  v_mul_f32 v85, 0x43800000, v79
  v_fma_f32 v76, -v33, v31, v76
  v_fma_f32 v77, -v33, v30, -v77
  v_exp_f32 v78, v78
  v_fract_f32 v79, v79
  v_exp_f32 v81, v81
  v_fract_f32 v82, v82
  v_exp_f32 v84, v84
  v_fract_f32 v85, v85
  v_sin_f32 v80, v79
  v_cos_f32 v79, v79
  v_sin_f32 v83, v82
  v_cos_f32 v82, v82
  v_sin_f32 v86, v85
  v_cos_f32 v85, v85
  v_and_b32 v87, 127, v0
  v_cmp_eq_u32 vcc, 0, v87
  v_mul_f32 v70, v78, v79
  v_mul_f32 v71, -v78, v80
  v_mul_f32 v72, v81, v82
  v_mul_f32 v73, v81, v83
  v_mul_f32_e64 v74, v84, v85
  v_mul_f32 v75, -v84, v86
  v_readfirstlane_b32 s58, v116
  s_mov_b32 m0, s58
  v_mov_b32 v88, 0x3f80
  v_cvt_pk_bf16_f32 v84, v72, v73
  v_cvt_pk_bf16_f32 v89, v76, v77
  ds_write_b32 v116, v88
  ds_write_addtid_b32 v84 offset:544
  ds_write_addtid_b32 v89 offset:17408
  v_pk_mul_f32 v[78:79], v[72:73], v[72:73] op_sel_hi:[1,0]
  v_pk_mul_f32 v[110:111], v[76:77], v[70:71] op_sel_hi:[1,0]
  v_pk_fma_f32 v[78:79], v[72:73], v[72:73], v[78:79] op_sel:[1,1,0] op_sel_hi:[0,1,1] neg_lo:[1,0,0]
  v_pk_fma_f32 v[110:111], v[76:77], v[70:71], v[110:111] op_sel:[1,1,0] op_sel_hi:[0,1,1] neg_lo:[1,0,0]
  v_cvt_pk_bf16_f32 v88, v78, v79
  v_cvt_pk_bf16_f32 v89, v110, v111
  ds_write_addtid_b32 v88 offset:1088
  ds_write_addtid_b32 v89 offset:17952
  v_pk_mul_f32 v[80:81], v[78:79], v[78:79] op_sel_hi:[1,0]
  v_pk_mul_f32 v[92:93], v[72:73], v[78:79] op_sel_hi:[1,0]
  v_pk_mul_f32 v[94:95], v[110:111], v[70:71] op_sel_hi:[1,0]
  v_pk_fma_f32 v[80:81], v[78:79], v[78:79], v[80:81] op_sel:[1,1,0] op_sel_hi:[0,1,1] neg_lo:[1,0,0]
  v_pk_fma_f32 v[92:93], v[72:73], v[78:79], v[92:93] op_sel:[1,1,0] op_sel_hi:[0,1,1] neg_lo:[1,0,0]
  v_pk_fma_f32 v[94:95], v[110:111], v[70:71], v[94:95] op_sel:[1,1,0] op_sel_hi:[0,1,1] neg_lo:[1,0,0]
  v_cvt_pk_bf16_f32 v88, v80, v81
  v_cvt_pk_bf16_f32 v84, v92, v93
  v_cvt_pk_bf16_f32 v89, v94, v95
  ds_write_addtid_b32 v88 offset:2176
  ds_write_addtid_b32 v84 offset:1632
  ds_write_addtid_b32 v89 offset:18496
  v_and_b32_e64 v255, 15, v0
  v_lshl_add_u32 v255, v255, 7, s37
  global_load_dword a223, v255, s[0:1]
  global_load_dword a221, v158, s[38:39]
  v_pk_mul_f32 v[82:83], v[80:81], v[78:79] op_sel_hi:[1,0]
  v_pk_mul_f32 v[90:91], v[92:93], v[78:79] op_sel_hi:[1,0]
  v_pk_mul_f32 v[110:111], v[94:95], v[70:71] op_sel_hi:[1,0]
  v_pk_fma_f32 v[82:83], v[80:81], v[78:79], v[82:83] op_sel:[1,1,0] op_sel_hi:[0,1,1] neg_lo:[1,0,0]
  v_pk_fma_f32 v[90:91], v[92:93], v[78:79], v[90:91] op_sel:[1,1,0] op_sel_hi:[0,1,1] neg_lo:[1,0,0]
  v_pk_fma_f32 v[110:111], v[94:95], v[70:71], v[110:111] op_sel:[1,1,0] op_sel_hi:[0,1,1] neg_lo:[1,0,0]
  v_cvt_pk_bf16_f32 v88, v82, v83
  v_cvt_pk_bf16_f32 v84, v90, v91
  v_cvt_pk_bf16_f32 v89, v110, v111
  ds_write_addtid_b32 v88 offset:3264
  ds_write_addtid_b32 v84 offset:2720
  ds_write_addtid_b32 v89 offset:19040
  v_pk_mul_f32 v[80:81], v[82:83], v[78:79] op_sel_hi:[1,0]
  v_pk_mul_f32 v[92:93], v[90:91], v[78:79] op_sel_hi:[1,0]
  v_pk_mul_f32 v[96:97], v[110:111], v[70:71] op_sel_hi:[1,0]
  v_pk_fma_f32 v[80:81], v[82:83], v[78:79], v[80:81] op_sel:[1,1,0] op_sel_hi:[0,1,1] neg_lo:[1,0,0]
  v_pk_fma_f32 v[92:93], v[90:91], v[78:79], v[92:93] op_sel:[1,1,0] op_sel_hi:[0,1,1] neg_lo:[1,0,0]
  v_pk_fma_f32 v[96:97], v[110:111], v[70:71], v[96:97] op_sel:[1,1,0] op_sel_hi:[0,1,1] neg_lo:[1,0,0]
  v_cvt_pk_bf16_f32 v88, v80, v81
  v_cvt_pk_bf16_f32 v84, v92, v93
  v_cvt_pk_bf16_f32 v89, v96, v97
  ds_write_addtid_b32 v88 offset:4352
  ds_write_addtid_b32 v84 offset:3808
  ds_write_addtid_b32 v89 offset:19584
  v_pk_mul_f32 v[82:83], v[80:81], v[78:79] op_sel_hi:[1,0]
  v_pk_mul_f32 v[90:91], v[92:93], v[78:79] op_sel_hi:[1,0]
  v_pk_mul_f32 v[110:111], v[96:97], v[70:71] op_sel_hi:[1,0]
  v_pk_fma_f32 v[82:83], v[80:81], v[78:79], v[82:83] op_sel:[1,1,0] op_sel_hi:[0,1,1] neg_lo:[1,0,0]
  v_pk_fma_f32 v[90:91], v[92:93], v[78:79], v[90:91] op_sel:[1,1,0] op_sel_hi:[0,1,1] neg_lo:[1,0,0]
  v_pk_fma_f32 v[110:111], v[96:97], v[70:71], v[110:111] op_sel:[1,1,0] op_sel_hi:[0,1,1] neg_lo:[1,0,0]
  v_cvt_pk_bf16_f32 v88, v82, v83
  v_cvt_pk_bf16_f32 v84, v90, v91
  v_cvt_pk_bf16_f32 v89, v110, v111
  ds_write_addtid_b32 v88 offset:5440
  ds_write_addtid_b32 v84 offset:4896
  ds_write_addtid_b32 v89 offset:20128
  v_pk_mul_f32 v[80:81], v[82:83], v[78:79] op_sel_hi:[1,0]
  v_pk_mul_f32 v[92:93], v[90:91], v[78:79] op_sel_hi:[1,0]
  v_pk_mul_f32 v[98:99], v[110:111], v[70:71] op_sel_hi:[1,0]
  v_pk_fma_f32 v[80:81], v[82:83], v[78:79], v[80:81] op_sel:[1,1,0] op_sel_hi:[0,1,1] neg_lo:[1,0,0]
  v_pk_fma_f32 v[92:93], v[90:91], v[78:79], v[92:93] op_sel:[1,1,0] op_sel_hi:[0,1,1] neg_lo:[1,0,0]
  v_pk_fma_f32 v[98:99], v[110:111], v[70:71], v[98:99] op_sel:[1,1,0] op_sel_hi:[0,1,1] neg_lo:[1,0,0]
  v_cvt_pk_bf16_f32 v88, v80, v81
  v_cvt_pk_bf16_f32 v84, v92, v93
  v_cvt_pk_bf16_f32 v89, v98, v99
  ds_write_addtid_b32 v88 offset:6528
  ds_write_addtid_b32 v84 offset:5984
  ds_write_addtid_b32 v89 offset:20672
  s_waitcnt vmcnt(12)
  s_nop 0
  v_perm_b32 v168, v16, v12, s49
  v_perm_b32 v169, v16, v12, s50
  v_perm_b32 v170, v17, v13, s49
  v_perm_b32 v171, v17, v13, s50
  v_perm_b32 v172, v18, v14, s49
  v_perm_b32 v173, v18, v14, s50
  v_perm_b32 v174, v19, v15, s49
  v_perm_b32 v175, v19, v15, s50
  v_dot2_f32_bf16 v160, v168, v54, 0
  v_dot2_f32_bf16 v161, v169, v54, 0
  v_dot2_f32_bf16 v162, v170, v54, 0
  v_dot2_f32_bf16 v163, v171, v54, 0
  v_dot2_f32_bf16 v164, v172, v54, 0
  v_dot2_f32_bf16 v165, v173, v54, 0
  v_dot2_f32_bf16 v166, v174, v54, 0
  v_dot2_f32_bf16 v167, v175, v54, 0
  v_perm_b32 v168, v24, v20, s49
  v_perm_b32 v169, v24, v20, s50
  v_perm_b32 v170, v25, v21, s49
  v_perm_b32 v171, v25, v21, s50
  v_perm_b32 v172, v26, v22, s49
  v_perm_b32 v173, v26, v22, s50
  v_perm_b32 v174, v27, v23, s49
  v_perm_b32 v175, v27, v23, s50
  v_dot2_f32_bf16 v160, v168, v55, v160
  v_dot2_f32_bf16 v161, v169, v55, v161
  v_dot2_f32_bf16 v162, v170, v55, v162
  v_dot2_f32_bf16 v163, v171, v55, v163
  v_dot2_f32_bf16 v164, v172, v55, v164
  v_dot2_f32_bf16 v165, v173, v55, v165
  v_dot2_f32_bf16 v166, v174, v55, v166
  v_dot2_f32_bf16 v167, v175, v55, v167
  ds_write_b128 v159, v[160:163]
  s_nop 1
  s_nop 0
  ds_write_b128 v159, v[164:167] offset:16
  v_pk_mul_f32 v[82:83], v[80:81], v[78:79] op_sel_hi:[1,0]
  v_pk_mul_f32 v[90:91], v[92:93], v[78:79] op_sel_hi:[1,0]
  v_pk_mul_f32 v[110:111], v[98:99], v[70:71] op_sel_hi:[1,0]
  v_pk_fma_f32 v[82:83], v[80:81], v[78:79], v[82:83] op_sel:[1,1,0] op_sel_hi:[0,1,1] neg_lo:[1,0,0]
  v_pk_fma_f32 v[90:91], v[92:93], v[78:79], v[90:91] op_sel:[1,1,0] op_sel_hi:[0,1,1] neg_lo:[1,0,0]
  v_pk_fma_f32 v[110:111], v[98:99], v[70:71], v[110:111] op_sel:[1,1,0] op_sel_hi:[0,1,1] neg_lo:[1,0,0]
  v_cvt_pk_bf16_f32 v88, v82, v83
  v_cvt_pk_bf16_f32 v84, v90, v91
  v_cvt_pk_bf16_f32 v89, v110, v111
  ds_write_addtid_b32 v88 offset:7616
  ds_write_addtid_b32 v84 offset:7072
  ds_write_addtid_b32 v89 offset:21216
  s_waitcnt lgkmcnt(0)
  s_barrier
  ds_read2st64_b32 v[176:177], v114 offset0:0 offset1:8
  ds_read2st64_b32 v[178:179], v114 offset0:1 offset1:9
  ds_read2st64_b32 v[180:181], v114 offset0:2 offset1:10
  ds_read2st64_b32 v[182:183], v114 offset0:16 offset1:24
  ds_read2st64_b32 v[184:185], v114 offset0:17 offset1:25
  ds_read2st64_b32 v[186:187], v114 offset0:18 offset1:26
  v_pk_mul_f32 v[80:81], v[82:83], v[78:79] op_sel_hi:[1,0]
  v_pk_mul_f32 v[92:93], v[90:91], v[78:79] op_sel_hi:[1,0]
  v_pk_mul_f32 v[100:101], v[110:111], v[70:71] op_sel_hi:[1,0]
  v_pk_fma_f32 v[80:81], v[82:83], v[78:79], v[80:81] op_sel:[1,1,0] op_sel_hi:[0,1,1] neg_lo:[1,0,0]
  v_pk_fma_f32 v[92:93], v[90:91], v[78:79], v[92:93] op_sel:[1,1,0] op_sel_hi:[0,1,1] neg_lo:[1,0,0]
  v_pk_fma_f32 v[100:101], v[110:111], v[70:71], v[100:101] op_sel:[1,1,0] op_sel_hi:[0,1,1] neg_lo:[1,0,0]
  v_cvt_pk_bf16_f32 v88, v80, v81
  v_cvt_pk_bf16_f32 v84, v92, v93
  ds_write_addtid_b32 v88 offset:8704
  ds_write_addtid_b32 v84 offset:8160
  s_waitcnt lgkmcnt(2)
  v_pk_add_f32 v[176:177], v[176:177], v[182:183]
  v_pk_add_f32 v[178:179], v[178:179], v[184:185]
  v_pk_add_f32 v[180:181], v[180:181], v[186:187]
  v_mov_b32 v191, v2
  v_add_f32 v188, v176, v177
  v_add_f32 v189, v178, v179
  v_add_f32_e64 v190, v180, v181
  s_mov_b32 exec_hi, 0
  buffer_store_dwordx4 v[188:191], v1, s[40:43], s60 offen sc1
  s_mov_b32 exec_hi, -1
  v_pk_mul_f32 v[82:83], v[80:81], v[78:79] op_sel_hi:[1,0]
  v_pk_mul_f32 v[90:91], v[92:93], v[78:79] op_sel_hi:[1,0]
  v_pk_mul_f32 v[102:103], v[100:101], v[74:75] op_sel_hi:[1,0]
  v_pk_fma_f32 v[82:83], v[80:81], v[78:79], v[82:83] op_sel:[1,1,0] op_sel_hi:[0,1,1] neg_lo:[1,0,0]
  v_pk_fma_f32 v[90:91], v[92:93], v[78:79], v[90:91] op_sel:[1,1,0] op_sel_hi:[0,1,1] neg_lo:[1,0,0]
  v_pk_fma_f32 v[102:103], v[100:101], v[74:75], v[102:103] op_sel:[1,1,0] op_sel_hi:[0,1,1] neg_lo:[1,0,0]
  v_cvt_pk_bf16_f32 v88, v82, v83
  v_cvt_pk_bf16_f32 v84, v90, v91
  v_cvt_pk_bf16_f32 v89, v102, v103
  ds_write_addtid_b32 v88 offset:9792
  ds_write_addtid_b32 v84 offset:9248
  ds_write_addtid_b32 v89 offset:23936
  v_pk_mul_f32 v[80:81], v[82:83], v[78:79] op_sel_hi:[1,0]
  v_pk_mul_f32 v[92:93], v[90:91], v[78:79] op_sel_hi:[1,0]
  v_pk_mul_f32 v[104:105], v[102:103], v[74:75] op_sel_hi:[1,0]
  v_pk_fma_f32 v[80:81], v[82:83], v[78:79], v[80:81] op_sel:[1,1,0] op_sel_hi:[0,1,1] neg_lo:[1,0,0]
  v_pk_fma_f32 v[92:93], v[90:91], v[78:79], v[92:93] op_sel:[1,1,0] op_sel_hi:[0,1,1] neg_lo:[1,0,0]
  v_pk_fma_f32 v[104:105], v[102:103], v[74:75], v[104:105] op_sel:[1,1,0] op_sel_hi:[0,1,1] neg_lo:[1,0,0]
  v_cvt_pk_bf16_f32 v88, v80, v81
  v_cvt_pk_bf16_f32 v84, v92, v93
  v_cvt_pk_bf16_f32 v89, v104, v105
  ds_write_addtid_b32 v88 offset:10880
  ds_write_addtid_b32 v84 offset:10336
  ds_write_addtid_b32 v89 offset:25024
  v_pk_mul_f32 v[82:83], v[80:81], v[78:79] op_sel_hi:[1,0]
  v_pk_mul_f32 v[90:91], v[92:93], v[78:79] op_sel_hi:[1,0]
  v_pk_mul_f32 v[102:103], v[104:105], v[74:75] op_sel_hi:[1,0]
  v_pk_fma_f32 v[82:83], v[80:81], v[78:79], v[82:83] op_sel:[1,1,0] op_sel_hi:[0,1,1] neg_lo:[1,0,0]
  v_pk_fma_f32 v[90:91], v[92:93], v[78:79], v[90:91] op_sel:[1,1,0] op_sel_hi:[0,1,1] neg_lo:[1,0,0]
  v_pk_fma_f32 v[102:103], v[104:105], v[74:75], v[102:103] op_sel:[1,1,0] op_sel_hi:[0,1,1] neg_lo:[1,0,0]
  v_cvt_pk_bf16_f32 v88, v82, v83
  v_cvt_pk_bf16_f32 v84, v90, v91
  v_cvt_pk_bf16_f32 v89, v102, v103
  ds_write_addtid_b32 v88 offset:11968
  ds_write_addtid_b32 v84 offset:11424
  ds_write_addtid_b32 v89 offset:26112
  v_pk_mul_f32 v[80:81], v[82:83], v[78:79] op_sel_hi:[1,0]
  v_pk_mul_f32 v[92:93], v[90:91], v[78:79] op_sel_hi:[1,0]
  v_pk_mul_f32 v[104:105], v[102:103], v[74:75] op_sel_hi:[1,0]
  v_pk_fma_f32 v[80:81], v[82:83], v[78:79], v[80:81] op_sel:[1,1,0] op_sel_hi:[0,1,1] neg_lo:[1,0,0]
  v_pk_fma_f32 v[92:93], v[90:91], v[78:79], v[92:93] op_sel:[1,1,0] op_sel_hi:[0,1,1] neg_lo:[1,0,0]
  v_pk_fma_f32 v[104:105], v[102:103], v[74:75], v[104:105] op_sel:[1,1,0] op_sel_hi:[0,1,1] neg_lo:[1,0,0]
  v_cvt_pk_bf16_f32 v88, v80, v81
  v_cvt_pk_bf16_f32 v84, v92, v93
  v_cvt_pk_bf16_f32 v89, v104, v105
  ds_write_addtid_b32 v88 offset:13056
  ds_write_addtid_b32 v84 offset:12512
  ds_write_addtid_b32 v89 offset:26656
  v_pk_mul_f32 v[82:83], v[80:81], v[78:79] op_sel_hi:[1,0]
  v_pk_mul_f32 v[90:91], v[92:93], v[78:79] op_sel_hi:[1,0]
  v_pk_mul_f32 v[102:103], v[104:105], v[74:75] op_sel_hi:[1,0]
  v_pk_fma_f32 v[82:83], v[80:81], v[78:79], v[82:83] op_sel:[1,1,0] op_sel_hi:[0,1,1] neg_lo:[1,0,0]
  v_pk_fma_f32 v[90:91], v[92:93], v[78:79], v[90:91] op_sel:[1,1,0] op_sel_hi:[0,1,1] neg_lo:[1,0,0]
  v_pk_fma_f32 v[102:103], v[104:105], v[74:75], v[102:103] op_sel:[1,1,0] op_sel_hi:[0,1,1] neg_lo:[1,0,0]
  v_cvt_pk_bf16_f32 v88, v82, v83
  v_cvt_pk_bf16_f32 v84, v90, v91
  v_cvt_pk_bf16_f32 v89, v102, v103
  ds_write_addtid_b32 v88 offset:14144
  ds_write_addtid_b32 v84 offset:13600
  ds_write_addtid_b32 v89 offset:27200
  v_pk_mul_f32 v[80:81], v[82:83], v[78:79] op_sel_hi:[1,0]
  v_pk_mul_f32 v[92:93], v[90:91], v[78:79] op_sel_hi:[1,0]
  v_pk_mul_f32 v[104:105], v[102:103], v[74:75] op_sel_hi:[1,0]
  v_pk_fma_f32 v[80:81], v[82:83], v[78:79], v[80:81] op_sel:[1,1,0] op_sel_hi:[0,1,1] neg_lo:[1,0,0]
  v_pk_fma_f32 v[92:93], v[90:91], v[78:79], v[92:93] op_sel:[1,1,0] op_sel_hi:[0,1,1] neg_lo:[1,0,0]
  v_pk_fma_f32 v[104:105], v[102:103], v[74:75], v[104:105] op_sel:[1,1,0] op_sel_hi:[0,1,1] neg_lo:[1,0,0]
  v_cvt_pk_bf16_f32 v88, v80, v81
  v_cvt_pk_bf16_f32 v84, v92, v93
  v_cvt_pk_bf16_f32 v89, v104, v105
  ds_write_addtid_b32 v88 offset:15232
  ds_write_addtid_b32 v84 offset:14688
  ds_write_addtid_b32 v89 offset:27744
  v_pk_mul_f32 v[82:83], v[80:81], v[78:79] op_sel_hi:[1,0]
  v_pk_mul_f32 v[90:91], v[92:93], v[78:79] op_sel_hi:[1,0]
  v_pk_mul_f32 v[102:103], v[104:105], v[74:75] op_sel_hi:[1,0]
  v_pk_fma_f32 v[82:83], v[80:81], v[78:79], v[82:83] op_sel:[1,1,0] op_sel_hi:[0,1,1] neg_lo:[1,0,0]
  v_pk_fma_f32 v[90:91], v[92:93], v[78:79], v[90:91] op_sel:[1,1,0] op_sel_hi:[0,1,1] neg_lo:[1,0,0]
  v_pk_fma_f32 v[102:103], v[104:105], v[74:75], v[102:103] op_sel:[1,1,0] op_sel_hi:[0,1,1] neg_lo:[1,0,0]
  v_cvt_pk_bf16_f32 v88, v82, v83
  v_cvt_pk_bf16_f32 v84, v90, v91
  v_cvt_pk_bf16_f32 v89, v102, v103
  ds_write_addtid_b32 v88 offset:16320
  ds_write_addtid_b32 v84 offset:15776
  ds_write_addtid_b32 v89 offset:28288
  v_pk_mul_f32 v[106:107], v[96:97], v[74:75] op_sel_hi:[1,0]
  v_pk_mul_f32 v[92:93], v[90:91], v[78:79] op_sel_hi:[1,0]
  v_pk_mul_f32 v[110:111], v[98:99], v[74:75] op_sel_hi:[1,0]
  v_pk_fma_f32 v[106:107], v[96:97], v[74:75], v[106:107] op_sel:[1,1,0] op_sel_hi:[0,1,1] neg_lo:[1,0,0]
  v_pk_fma_f32 v[92:93], v[90:91], v[78:79], v[92:93] op_sel:[1,1,0] op_sel_hi:[0,1,1] neg_lo:[1,0,0]
  v_pk_fma_f32 v[110:111], v[98:99], v[74:75], v[110:111] op_sel:[1,1,0] op_sel_hi:[0,1,1] neg_lo:[1,0,0]
  v_cvt_pk_bf16_f32 v88, v106, v107
  v_cvt_pk_bf16_f32 v84, v92, v93
  v_cvt_pk_bf16_f32 v89, v110, v111
  ds_write_addtid_b32 v88 offset:22848
  ds_write_addtid_b32 v84 offset:16864
  ds_write_addtid_b32 v89 offset:23392
  v_pk_mul_f32 v[108:109], v[106:107], v[74:75] op_sel_hi:[1,0]
  v_pk_mul_f32 v[90:91], v[76:77], v[74:75] op_sel_hi:[1,0]
  v_mov_b32 v13, s80
  v_pk_fma_f32 v[108:109], v[106:107], v[74:75], v[108:109] op_sel:[1,1,0] op_sel_hi:[0,1,1] neg_lo:[1,0,0]
  v_pk_fma_f32 v[90:91], v[76:77], v[74:75], v[90:91] op_sel:[1,1,0] op_sel_hi:[0,1,1] neg_lo:[1,0,0]
  v_mov_b32 v14, 0
  v_cvt_pk_bf16_f32 v88, v108, v109
  v_cvt_pk_bf16_f32 v84, v90, v91
  v_cndmask_b32 v12, 0, v13, vcc
  ds_write_addtid_b32 v88 offset:24480
  ds_write_addtid_b32 v84 offset:21760
  v_mov_b32 v13, 0
  v_pk_mul_f32 v[106:107], v[108:109], v[74:75] op_sel_hi:[1,0]
  v_pk_mul_f32 v[92:93], v[94:95], v[74:75] op_sel_hi:[1,0]
  v_mov_b32_e64 v15, 0
  v_pk_fma_f32 v[106:107], v[108:109], v[74:75], v[106:107] op_sel:[1,1,0] op_sel_hi:[0,1,1] neg_lo:[1,0,0]
  v_pk_fma_f32 v[92:93], v[94:95], v[74:75], v[92:93] op_sel:[1,1,0] op_sel_hi:[0,1,1] neg_lo:[1,0,0]
  v_mul_f32 v66, 0x51800000, v67
  v_cvt_pk_bf16_f32 v88, v106, v107
  v_cvt_pk_bf16_f32 v84, v92, v93
  v_max_f32 v66, 0x1f800000, v66
  ds_write_addtid_b32 v88 offset:25568
  ds_write_addtid_b32 v84 offset:22304
  v_mov_b32 v26, v252
  v_mov_b32 v27, v253
  s_waitcnt lgkmcnt(0)
  s_barrier
  ds_read_b128 v[160:163], v117 offset:0
  s_lshr_b32 s58, s44, 6
  s_bfe_u32 s61, s44, 0x10001
  ds_read_b128 v[164:167], v118 offset:17408
  s_lshl1_add_u32 s58, s58, s61
  s_bfe_u32 s61, s44, 0x40002
  ds_read_b128 v[168:171], v119 offset:23936
  s_lshl4_add_u32 s58, s58, s61
  s_and_b32 s61, s44, 1
  ds_read_b128 v[172:175], v117 offset:64
  s_lshl3_add_u32 s58, s58, s61
  s_lshl_b32 s58, s58, 3
  ds_read_b128 v[176:179], v118 offset:17472
  s_add_u32 s4, s58, 1441792
  s_add_u32 s5, s58, 1982464
  ds_read_b128 v[180:183], v119 offset:24000
  s_add_u32 s6, s58, 2523136
  s_add_u32 s7, s58, 3063808
  ds_read_b128 v[184:187], v117 offset:128
  s_and_b32 s58, s2, 7
  s_lshl_b32 s58, s58, 10
  ds_read_b128 v[188:191], v118 offset:17536
  s_add_u32 s58, s58, s3
  s_lshl_b32 s58, s58, 6
  ds_read_b128 v[192:195], v119 offset:24064
  s_add_u32 s8, s58, 917504
  s_add_u32 s9, s58, 950272
  ds_read_b128 v[196:199], v117 offset:192
  ds_read_b128 v[200:203], v118 offset:17600
  ds_read_b128 v[204:207], v119 offset:24128
  buffer_load_dwordx2 v[28:29], v64, s[40:43], s4 offen sc1
  buffer_load_dwordx2 v[30:31], v64, s[40:43], s5 offen sc1
  buffer_load_dwordx2 v[32:33], v64, s[40:43], s6 offen sc1
  buffer_load_dwordx2 v[34:35], v64, s[40:43], s7 offen sc1
  s_waitcnt lgkmcnt(9)
  v_mfma_f32_16x16x32_bf16 v[12:15], v[160:163], v[164:167], v[12:15]
  ds_read_b128 v[208:211], v117 offset:256
  ds_read_b128 v[212:215], v118 offset:17664
  s_and_b32 s58, s65, 127
  s_mul_i32 s58, s58, 28
  v_mfma_f32_16x16x32_bf16 v[16:19], v[160:163], v[168:171], 0
  ds_read_b128 v[216:219], v119 offset:24192
  s_bfe_u32 s61, s2, 65537
  s_add_u32 s58, s58, s61
  s_waitcnt lgkmcnt(9)
  v_mfma_f32_16x16x32_bf16 v[12:15], v[172:175], v[176:179], v[12:15]
  ds_read_b128 v[220:223], v117 offset:320
  ds_read_b128 v[224:227], v118 offset:17728
  s_lshl_b32 s58, s58, 9
  s_add_u32 s15, s58, 384
  v_mfma_f32_16x16x32_bf16 v[16:19], v[172:175], v[180:183], v[16:19]
  ds_read_b128 v[228:231], v119 offset:24256
  s_lshr_b32 s58, s65, 5
  s_lshl_b32 s58, s58, 6
  s_waitcnt lgkmcnt(9)
  v_mfma_f32_16x16x32_bf16 v[12:15], v[184:187], v[188:191], v[12:15]
  ds_read_b128 v[232:235], v117 offset:384
  ds_read_b128 v[236:239], v118 offset:17792
  s_bfe_u32 s61, s65, 0x40001
  s_add_u32 s58, s58, s61
  v_mfma_f32_16x16x32_bf16 v[16:19], v[184:187], v[192:195], v[16:19]
  ds_read_b128 v[240:243], v119 offset:24320
  s_lshl_b32 s58, s58, 11
  s_add_u32 s14, s14, s58
  s_waitcnt lgkmcnt(9)
  v_mfma_f32_16x16x32_bf16 v[12:15], v[196:199], v[200:203], v[12:15]
  ds_read_b128 v[244:247], v117 offset:448
  ds_read_b128 v[248:251], v118 offset:17856
  s_add_u32 s14, s14, 10092544
  s_cmp_ge_u32 s44, 224
  s_cselect_b32 s14, 268435456, s14
  v_mfma_f32_16x16x32_bf16 v[16:19], v[196:199], v[204:207], v[16:19]
  ds_read_b128 v[252:255], v119 offset:24384
  s_bfe_u32 s58, s44, 65542
  s_and_b32 s55, s44, 3
  s_waitcnt lgkmcnt(9)
  v_mfma_f32_16x16x32_bf16 v[12:15], v[208:211], v[212:215], v[12:15]
  s_lshl2_add_u32 s55, s58, s55
  s_lshl_b32 s58, s55, 7
  v_mfma_f32_16x16x32_bf16 v[16:19], v[208:211], v[216:219], v[16:19]
  s_add_u32 s28, s28, s58
  s_addc_u32 s29, s29, 0
  s_lshl_b32 s36, s45, 13
  s_waitcnt lgkmcnt(6)
  v_mfma_f32_16x16x32_bf16 v[12:15], v[220:223], v[224:227], v[12:15]
  v_add_u32_sdwa v56, s67, v152 dst_sel:DWORD dst_unused:UNUSED_PAD src0_sel:DWORD src1_sel:WORD_0
  v_add_u32_sdwa v57, s67, v152 dst_sel:DWORD dst_unused:UNUSED_PAD src0_sel:DWORD src1_sel:WORD_1
  v_mfma_f32_16x16x32_bf16 v[16:19], v[220:223], v[228:231], v[16:19]
  v_add_u32_sdwa v58, s67, v153 dst_sel:DWORD dst_unused:UNUSED_PAD src0_sel:DWORD src1_sel:WORD_0
  v_add_u32_sdwa v59, s67, v153 dst_sel:DWORD dst_unused:UNUSED_PAD src0_sel:DWORD src1_sel:WORD_1
  s_waitcnt lgkmcnt(3)
  v_mfma_f32_16x16x32_bf16 v[12:15], v[232:235], v[236:239], v[12:15]
  v_add_u32_sdwa v60, s67, v154 dst_sel:DWORD dst_unused:UNUSED_PAD src0_sel:DWORD src1_sel:WORD_0
  v_add_u32_sdwa v61, s67, v154 dst_sel:DWORD dst_unused:UNUSED_PAD src0_sel:DWORD src1_sel:WORD_1
  v_mfma_f32_16x16x32_bf16 v[16:19], v[232:235], v[240:243], v[16:19]
  v_add_u32_sdwa v62, s67, v155 dst_sel:DWORD dst_unused:UNUSED_PAD src0_sel:DWORD src1_sel:WORD_0
  v_add_u32_sdwa v126, 0, v155 dst_sel:DWORD dst_unused:UNUSED_PAD src0_sel:DWORD src1_sel:WORD_1
  s_waitcnt lgkmcnt(0)
  v_mfma_f32_16x16x32_bf16 v[12:15], v[244:247], v[248:251], v[12:15]
  v_mfma_f32_16x16x32_bf16 v[16:19], v[244:247], v[252:255], v[16:19]
  buffer_load_dwordx4 v[84:87], v115, s[40:43], s8 offen sc1
  buffer_load_dwordx4 v[88:91], v115, s[40:43], s9 offen sc1
  ds_read2_b32 v[196:197], v122 offset0:6 offset1:4
  ds_read2_b32 v[198:199], v122 offset0:2 offset1:0
  ds_read2_b32 v[200:201], v122 offset0:70 offset1:68
  ds_read2_b32 v[202:203], v122 offset0:66 offset1:64
  ds_read2_b32 v[204:205], v123 offset0:134 offset1:132
  ds_read2_b32 v[206:207], v123 offset0:130 offset1:128
  v_cvt_pk_bf16_f32 v20, v12, v13
  v_cvt_pk_bf16_f32 v21, v14, v15
  v_cvt_pk_bf16_f32 v22, v16, v17
  v_cvt_pk_bf16_f32 v23, v18, v19
  ds_write_b16 v120, v20 offset:0
  ds_write_b16 v120, v20 offset:6
  ds_write_b16_d16_hi v120, v20 offset:32
  ds_write_b16_d16_hi v120, v20 offset:38
  ds_write_b16 v120, v21 offset:64
  ds_write_b16 v120, v21 offset:70
  ds_write_b16_d16_hi v120, v21 offset:96
  ds_write_b16_d16_hi v120, v21 offset:102
  ds_write_b16_d16_hi v121, v23 offset:932
  ds_write_b16_d16_hi v121, v23 offset:938
  s_mov_b32 exec_lo, 0x00ff00ff
  s_mov_b32 exec_hi, 0x00ff00ff
  ds_write_b16 v121, v22 offset:0
  ds_write_b16 v121, v22 offset:6
  ds_write_b16_d16_hi v121, v22 offset:928
  ds_write_b16_d16_hi v121, v22 offset:934
  ds_write_b16 v121, v23 offset:4
  ds_write_b16 v121, v23 offset:10
  s_mov_b64 exec, -1
  v_add_u32 v55, 1024, v56
  s_waitcnt lgkmcnt(0)
  s_barrier
  s_nop 0
  ds_read2_b32 v[128:129], v56 offset0:6 offset1:4
  ds_read2_b32 v[130:131], v56 offset0:2 offset1:0
  ds_read2_b32 v[132:133], v55 offset0:6 offset1:4
  ds_read2_b32 v[134:135], v55 offset0:2 offset1:0
  ds_read2_b32 v[136:137], v56 offset0:38 offset1:36
  ds_read2_b32 v[138:139], v56 offset0:34 offset1:32
  ds_read2_b32 v[140:141], v55 offset0:38 offset1:36
  ds_read2_b32 v[142:143], v55 offset0:34 offset1:32
  s_waitcnt vmcnt(11)
  s_nop 0
  v_perm_b32 v216, v38, v36, s49
  ds_read2_b32 v[144:145], v56 offset0:70 offset1:68
  v_perm_b32 v217, v42, v40, s49
  ds_read2_b32 v[146:147], v56 offset0:66 offset1:64
  v_perm_b32 v218, v46, v44, s49
  ds_read2_b32 v[148:149], v55 offset0:70 offset1:68
  v_perm_b32 v219, v50, v48, s49
  ds_read2_b32 v[150:151], v55 offset0:66 offset1:64
  v_add_u32 v216, 0x20002000, v216
  ds_read2_b32 v[152:153], v56 offset0:102 offset1:100
  v_add_u32 v217, 0x20002000, v217
  ds_read2_b32 v[154:155], v56 offset0:98 offset1:96
  v_perm_b32 v220, v38, v36, s50
  ds_read2_b32 v[156:157], v55 offset0:102 offset1:100
  v_perm_b32 v221, v42, v40, s50
  ds_read2_b32 v[158:159], v55 offset0:98 offset1:96
  v_perm_b32 v222, v46, v44, s50
  ds_read2_b32 v[160:161], v57 offset0:6 offset1:4
  v_perm_b32 v223, v50, v48, s50
  ds_read2_b32 v[162:163], v57 offset0:2 offset1:0
  v_add_u32 v220, 0x20002000, v220
  ds_read2_b32 v[164:165], v57 offset0:54 offset1:52
  v_add_u32 v221, 0x20002000, v221
  ds_read2_b32 v[166:167], v57 offset0:50 offset1:48
  v_perm_b32 v224, v39, v37, s49
  ds_read2_b32 a[192:193], v58 offset0:4 offset1:2
  v_perm_b32 v225, v43, v41, s49
  ds_read2_b32 a[194:195], v58 offset0:68 offset1:66
  v_perm_b32 v226, v47, v45, s49
  ds_read2_b32 a[196:197], v58 offset0:20 offset1:18
  v_perm_b32 v227, v51, v49, s49
  ds_read2_b32 a[198:199], v58 offset0:84 offset1:82
  v_add_u32 v224, 0x20002000, v224
  ds_read2_b32 a[200:201], v58 offset0:36 offset1:34
  v_add_u32 v225, 0x20002000, v225
  ds_read2_b32 a[202:203], v58 offset0:100 offset1:98
  v_perm_b32 v228, v39, v37, s50
  ds_read2_b32 a[204:205], v58 offset0:148 offset1:146
  v_perm_b32 v229, v43, v41, s50
  ds_read2_b32 a[206:207], v58 offset0:132 offset1:130
  v_perm_b32 v230, v47, v45, s50
  ds_read2_b32 a[208:209], v58 offset0:164 offset1:162
  v_perm_b32 v231, v51, v49, s50
  ds_read2_b32 a[210:211], v58 offset0:148 offset1:146
  v_add_u32 v228, 0x20002000, v228
  ds_read2_b32 a[212:213], v58 offset0:180 offset1:178
  v_add_u32 v229, 0x20002000, v229
  ds_read2_b32 a[214:215], v58 offset0:164 offset1:162
  s_waitcnt vmcnt(0)
L_e1chk:
  v_xor_b32 v76, v28, v26
  v_xor_b32 v77, v29, v27
  v_xor_b32 v78, v30, v26
  v_xor_b32 v79, v31, v27
  v_xor_b32 v80, v32, v26
  v_xor_b32 v81, v33, v27
  v_xor_b32 v82, v34, v26
  v_xor_b32 v83, v35, v27
  v_cmp_ne_u32 s[56:57], v87, v2
  v_or3_b32 v92, v76, v77, v78
  v_or3_b32 v93, v79, v80, v81
  v_cmp_ne_u32 vcc, v91, v2
  v_or3_b32 v92, v92, v82, v83
  s_or_b64 s[56:57], s[56:57], vcc
  v_bitop3_b32 v92, v92, v93, s25 bitop3:0xa8
  v_cmp_ne_u32 vcc, 0, v92
  s_or_b64 s[56:57], s[56:57], vcc
  s_cbranch_scc1 L_e1retry
  v_add_f32 v28, v84, v88
  v_add_f32 v29, v85, v89
  v_add_f32 v30, v86, v90
  v_mov_b32 v31, 0
  v_lshlrev_b32 v96, 16, v76
  ds_read2_b32 a[216:217], v58 offset0:196 offset1:194
  v_lshlrev_b32 v97, 16, v77
  ds_read2_b32 a[218:219], v58 offset0:180 offset1:178
  v_permlane32_swap_b32 v28, v29
  v_permlane32_swap_b32 v30, v31
  v_add_f32 v28, v28, v29
  v_add_f32 v30, v30, v31
  v_and_b32 v98, s47, v76
  v_and_b32 v99, s47, v77
  v_permlane16_swap_b32 v28, v30
  v_add_f32 v28, v28, v30
  v_lshlrev_b32 v100, 16, v78
  v_lshlrev_b32 v101, 16, v79
  v_add_f32_dpp v28, v28, v28 row_ror:4 row_mask:0xf bank_mask:0xf
  v_and_b32 v102, s47, v78
  v_and_b32 v103, s47, v79
  v_add_f32_dpp v28, v28, v28 row_ror:8 row_mask:0xf bank_mask:0xf
  v_cvt_pk_bf16_f32 v28, v28, v28
  v_and_b32 v28, s47, v28
  v_add_f32 v29, v28, v67
  v_readlane_b32 s72, v28, 16
  v_readlane_b32 s73, v28, 17
  v_cvt_pk_bf16_f32 v28, v29, v29
  v_and_b32 v28, s47, v28
  v_mul_f32 v31, v66, v28
  v_mul_f32 v29, s72, v31
  v_mul_f32 v30, s73, v31
  v_readlane_b32 s68, v29, 32
  v_readlane_b32 s69, v29, 0
  v_readlane_b32 s70, v30, 33
  v_readlane_b32 s71, v30, 1
  v_lshlrev_b32 v104, 16, v80
  v_lshlrev_b32 v105, 16, v81
  v_and_b32 v106, s47, v80
  v_and_b32 v107, s47, v81
  v_lshlrev_b32 v108, 16, v82
  v_lshlrev_b32 v109, 16, v83
  v_and_b32 v110, s47, v82
  v_and_b32 v111, s47, v83
  v_pk_fma_f32 v[96:97], v[96:97], s[68:69], s[68:69] op_sel:[0,0,1] op_sel_hi:[1,0,1]
  v_pk_fma_f32 v[98:99], v[98:99], s[70:71], s[70:71] op_sel:[0,0,1] op_sel_hi:[1,0,1]
  v_cvt_pk_bf16_f32 v30, v96, v97
  ds_write_b32 v63, v30 offset:0
  v_cvt_pk_bf16_f32 v31, v98, v99
  ds_write_b32 v63, v31 offset:4608
  v_pk_fma_f32 v[100:101], v[100:101], s[68:69], s[68:69] op_sel:[0,0,1] op_sel_hi:[1,0,1]
  v_pk_fma_f32 v[102:103], v[102:103], s[70:71], s[70:71] op_sel:[0,0,1] op_sel_hi:[1,0,1]
  v_cvt_pk_bf16_f32 v30, v100, v101
  ds_write_b32 v63, v30 offset:1024
  v_cvt_pk_bf16_f32 v31, v102, v103
  ds_write_b32 v63, v31 offset:5632
  v_pk_fma_f32 v[104:105], v[104:105], s[68:69], s[68:69] op_sel:[0,0,1] op_sel_hi:[1,0,1]
  v_pk_fma_f32 v[106:107], v[106:107], s[70:71], s[70:71] op_sel:[0,0,1] op_sel_hi:[1,0,1]
  v_cvt_pk_bf16_f32 v30, v104, v105
  ds_write_b32 v63, v30 offset:2048
  v_cvt_pk_bf16_f32 v31, v106, v107
  ds_write_b32 v63, v31 offset:6656
  v_pk_fma_f32 v[108:109], v[108:109], s[68:69], s[68:69] op_sel:[0,0,1] op_sel_hi:[1,0,1]
  v_pk_fma_f32 v[110:111], v[110:111], s[70:71], s[70:71] op_sel:[0,0,1] op_sel_hi:[1,0,1]
  v_cvt_pk_bf16_f32 v30, v108, v109
  ds_write_b32 v63, v30 offset:3072
  v_cvt_pk_bf16_f32 v31, v110, v111
  ds_write_b32 v63, v31 offset:7680
  s_waitcnt lgkmcnt(0)
  s_barrier
  v_min_u32 v94, 208, v1
  v_lshl_add_u32 v94, v94, 6, s15
  global_load_dword a222, v94, s[0:1]
  ds_read_b128 v[72:75], v59 offset:0
  ds_read_b128 v[76:79], v59 offset:512
  ds_read_b128 v[96:99], v62 offset:192
  ds_read_b128 v[100:103], v62 offset:128
  ds_read_b128 v[104:107], v62 offset:64
  ds_read_b128 v[108:111], v62 offset:0
  ds_read_b128 v[116:119], v62 offset:704
  ds_read_b128 v[120:123], v62 offset:640
  s_waitcnt lgkmcnt(7)
  v_mfma_f32_16x16x32_bf16 v[240:243], v[72:75], v[196:199], 0
  ds_read_b128 v[168:171], v62 offset:576
  ds_read_b128 v[172:175], v62 offset:512
  v_mfma_f32_16x16x32_bf16 v[244:247], v[72:75], v[200:203], 0
  s_add_u32 m0, s36, 0
  s_nop 0
  global_load_lds_dwordx4 v65, s[28:29] offset:0
  s_bitcmp1_b32 s44, 1
  s_cselect_b32 s58, 1.0, 0x1f800000
  s_waitcnt lgkmcnt(8)
  v_mfma_f32_16x16x32_bf16 v[248:251], v[76:79], v[196:199], 0
  v_cvt_pk_bf16_f32 v208, v240, v241
  v_cvt_pk_bf16_f32 v209, v242, v243
  v_mfma_f32_16x16x32_bf16 v[252:255], v[76:79], v[200:203], 0
  v_cvt_pk_bf16_f32 v210, v244, v245
  v_cvt_pk_bf16_f32 v211, v246, v247
  s_waitcnt lgkmcnt(7)
  v_mfma_f32_16x16x32_bf16 a[224:227], v[128:131], v[96:99], 0
  buffer_store_dwordx4 v[216:219], v124, s[40:43], s14 offen sc1
  s_add_u32 s14, s14, 32768
  ds_read_b128 v[176:179], v62 offset:1216
  v_mfma_f32_16x16x32_bf16 a[228:231], v[132:135], v[96:99], 0
  v_cvt_pk_bf16_f32 v212, v248, v249
  v_cvt_pk_bf16_f32 v213, v250, v251
  s_waitcnt lgkmcnt(7)
  v_mfma_f32_16x16x32_bf16 a[224:227], v[136:139], v[100:103], a[224:227]
  ds_read_b128 v[180:183], v62 offset:1152
  v_cvt_pk_bf16_f32 v214, v252, v253
  v_mfma_f32_16x16x32_bf16 a[228:231], v[140:143], v[100:103], a[228:231]
  buffer_store_dwordx4 v[220:223], v124, s[40:43], s14 offen sc1
  s_add_u32 s14, s14, 32768
  v_cvt_pk_bf16_f32 v215, v254, v255
  s_waitcnt lgkmcnt(7)
  v_mfma_f32_16x16x32_bf16 a[224:227], v[144:147], v[104:107], a[224:227]
  ds_read_b128 v[184:187], v62 offset:1088
  v_mul_f32 v29, s58, v28
  v_mfma_f32_16x16x32_bf16 a[228:231], v[148:151], v[104:107], a[228:231]
  v_readlane_b32 s79, v28, 19
  v_readlane_b32 s78, v28, 18
  s_waitcnt lgkmcnt(7)
  v_mfma_f32_16x16x32_bf16 a[224:227], v[152:155], v[108:111], a[224:227]
  buffer_store_dwordx4 v[224:227], v124, s[40:43], s14 offen sc1
  s_add_u32 s14, s14, 32768
  ds_read_b128 v[188:191], v62 offset:1024
  v_mfma_f32_16x16x32_bf16 a[228:231], v[156:159], v[108:111], a[228:231]
  v_readlane_b32 s77, v29, 3
  v_readlane_b32 s76, v29, 2
  s_waitcnt lgkmcnt(7)
  v_mfma_f32_16x16x32_bf16 a[228:231], v[128:131], v[116:119], a[228:231]
  ds_read_b128 v[80:83], v59 offset:1024
  ds_write_b128 v60, a[224:227] offset:0
  v_mfma_f32_16x16x32_bf16 a[232:235], v[132:135], v[116:119], 0
  buffer_store_dwordx4 v[228:231], v124, s[40:43], s14 offen sc1
  v_readlane_b32 s75, v29, 35
  s_waitcnt lgkmcnt(8)
  v_mfma_f32_16x16x32_bf16 a[228:231], v[136:139], v[120:123], a[228:231]
  v_readlane_b32 s74, v29, 34
  v_and_b32 v69, 3, v0
  v_mfma_f32_16x16x32_bf16 a[232:235], v[140:143], v[120:123], a[232:235]
  s_pack_hh_b32_b16 s58, s74, s75
  s_pack_hh_b32_b16 s59, s76, s77
  s_waitcnt lgkmcnt(7)
  v_mfma_f32_16x16x32_bf16 a[228:231], v[144:147], v[168:171], a[228:231]
  s_pack_hh_b32_b16 s60, s78, s79
  v_lshlrev_b32 v69, 2, v69
  v_mfma_f32_16x16x32_bf16 a[232:235], v[148:151], v[168:171], a[232:235]
  ds_read_b128 v[96:99], v62 offset:1728
  s_mov_b32 s25, 1073758208
  s_waitcnt lgkmcnt(7)
  v_mfma_f32_16x16x32_bf16 a[228:231], v[152:155], v[172:175], a[228:231]
  ds_read_b128 v[100:103], v62 offset:1664
  v_alignbit_b32 v69, v2, v2, v69
  v_mfma_f32_16x16x32_bf16 a[232:235], v[156:159], v[172:175], a[232:235]
  global_load_lds_dwordx4 v65, s[28:29] offset:1024
  ds_read_b128 v[104:107], v62 offset:1600
  v_mfma_f32_16x16x32_bf16 a[232:235], v[160:163], v[72:75], a[232:235]
  ds_read_b128 v[108:111], v62 offset:1536
  v_xor_b32 v64, 32, v61
  v_mfma_f32_16x16x32_bf16 a[232:235], v[208:211], a[192:195], a[232:235]
  ds_read_b128 v[84:87], v59 offset:1536
  ds_write_b128 v60, a[228:231] offset:1024
  v_mfma_f32_16x16x32_bf16 v[240:243], v[72:75], v[204:207], 0
  v_add_u32 v125, 65536, v126
  v_and_b32 v16, s25, v69
  v_mfma_f32_16x16x32_bf16 v[244:247], v[76:79], v[204:207], 0
  v_alignbit_b32 v17, v69, v69, 1
  v_alignbit_b32 v18, v69, v69, 2
  s_waitcnt lgkmcnt(11)
  v_mfma_f32_16x16x32_bf16 a[232:235], v[128:131], v[176:179], a[232:235]
  v_alignbit_b32 v19, v69, v69, 3
  v_cvt_pk_bf16_f32 v232, v240, v241
  v_mfma_f32_16x16x32_bf16 a[236:239], v[132:135], v[176:179], 0
  global_load_lds_dwordx4 v65, s[28:29] offset:2048
  v_cvt_pk_bf16_f32 v233, v242, v243
  s_waitcnt lgkmcnt(10)
  v_mfma_f32_16x16x32_bf16 a[232:235], v[136:139], v[180:183], a[232:235]
  v_cvt_pk_bf16_f32 v234, v244, v245
  v_cvt_pk_bf16_f32 v235, v246, v247
  v_mfma_f32_16x16x32_bf16 a[236:239], v[140:143], v[180:183], a[236:239]
  v_and_b32 v17, s25, v17
  v_and_b32 v18, s25, v18
  s_waitcnt lgkmcnt(9)
  v_mfma_f32_16x16x32_bf16 a[232:235], v[144:147], v[184:187], a[232:235]
  v_and_b32 v19, s25, v19
  v_mov_b32 v192, s58
  v_mfma_f32_16x16x32_bf16 a[236:239], v[148:151], v[184:187], a[236:239]
  v_mov_b32 v193, s59
  v_mov_b32 v194, s60
  s_waitcnt lgkmcnt(8)
  v_mfma_f32_16x16x32_bf16 a[232:235], v[152:155], v[188:191], a[232:235]
  v_mov_b32 v195, v2
  ds_read_b128 v[116:119], v62 offset:2240
  v_mfma_f32_16x16x32_bf16 a[236:239], v[156:159], v[188:191], a[236:239]
  global_load_lds_dwordx4 v65, s[28:29] offset:3072
  ds_read_b128 v[120:123], v62 offset:2176
  s_waitcnt lgkmcnt(9)
  v_mfma_f32_16x16x32_bf16 v[248:251], v[80:83], v[196:199], 0
  ds_read_b128 v[168:171], v62 offset:2112
  ds_write_b128 v60, a[232:235] offset:2048
  v_mfma_f32_16x16x32_bf16 v[252:255], v[80:83], v[200:203], 0
  ds_read_b128 v[172:175], v62 offset:2048
  ds_read_b128 v[176:179], v62 offset:2752
  v_mfma_f32_16x16x32_bf16 a[236:239], v[160:163], v[76:79], a[236:239]
  ds_read_b128 v[180:183], v62 offset:2688
  ds_read_b128 v[184:187], v62 offset:2624
  v_mfma_f32_16x16x32_bf16 a[236:239], v[208:211], a[196:199], a[236:239]
  v_cvt_pk_bf16_f32 v216, v248, v249
  v_cvt_pk_bf16_f32 v217, v250, v251
  v_mfma_f32_16x16x32_bf16 a[236:239], v[212:215], a[192:195], a[236:239]
  v_cvt_pk_bf16_f32 v218, v252, v253
  v_cvt_pk_bf16_f32 v219, v254, v255
  s_waitcnt lgkmcnt(13)
  v_mfma_f32_16x16x32_bf16 a[236:239], v[128:131], v[96:99], a[236:239]
  s_add_u32 m0, s36, 4096
  v_add_u32 v65, 32768, v65
  global_load_lds_dwordx4 v65, s[28:29] offset:0
  ds_read_b128 v[188:191], v62 offset:2560
  s_waitcnt lgkmcnt(13)
  v_mfma_f32_16x16x32_bf16 a[236:239], v[136:139], v[100:103], a[236:239]
  ds_read_b128 v[88:91], v59 offset:2048
  ds_read_b128 v[92:95], v59 offset:2560
  s_waitcnt lgkmcnt(14)
  v_mfma_f32_16x16x32_bf16 a[236:239], v[144:147], v[104:107], a[236:239]
  s_waitcnt lgkmcnt(13)
  v_mfma_f32_16x16x32_bf16 a[236:239], v[152:155], v[108:111], a[236:239]
  s_waitcnt lgkmcnt(12)
  v_mfma_f32_16x16x32_bf16 v[240:243], v[84:87], v[196:199], 0
  v_mfma_f32_16x16x32_bf16 v[244:247], v[84:87], v[200:203], 0
  v_mfma_f32_16x16x32_bf16 a[240:243], v[132:135], v[96:99], 0
  global_load_lds_dwordx4 v65, s[28:29] offset:1024
  v_mfma_f32_16x16x32_bf16 a[240:243], v[140:143], v[100:103], a[240:243]
  ds_read_b128 v[96:99], v62 offset:3264
  v_mfma_f32_16x16x32_bf16 a[240:243], v[148:151], v[104:107], a[240:243]
  ds_write_b128 v60, a[236:239] offset:3072
  ds_read_b128 v[100:103], v62 offset:3200
  v_mfma_f32_16x16x32_bf16 a[240:243], v[156:159], v[108:111], a[240:243]
  v_cvt_pk_bf16_f32 v220, v240, v241
  v_cvt_pk_bf16_f32 v221, v242, v243
  v_mfma_f32_16x16x32_bf16 a[240:243], v[160:163], v[80:83], a[240:243]
  v_cvt_pk_bf16_f32 v222, v244, v245
  v_cvt_pk_bf16_f32 v223, v246, v247
  v_mfma_f32_16x16x32_bf16 a[240:243], v[164:167], v[72:75], a[240:243]
  s_waitcnt lgkmcnt(1)
  s_barrier
  v_mfma_f32_16x16x32_bf16 a[240:243], v[208:211], a[200:203], a[240:243]
  global_load_lds_dwordx4 v65, s[28:29] offset:2048
  ds_read_b64 v[28:29], v61 offset:0
  v_mfma_f32_16x16x32_bf16 a[240:243], v[212:215], a[196:199], a[240:243]
  ds_read_b64 v[30:31], v61 offset:8192
  ds_read_b64 v[32:33], v61 offset:16384
  v_mfma_f32_16x16x32_bf16 a[240:243], v[216:219], a[192:195], a[240:243]
  ds_read_b64 v[34:35], v61 offset:24576
  ds_read_b64 v[240:241], v64 offset:0
  v_mfma_f32_16x16x32_bf16 a[240:243], v[232:235], a[204:207], a[240:243]
  ds_read_b64 v[242:243], v64 offset:8192
  ds_read_b64 v[244:245], v64 offset:16384
  v_mfma_f32_16x16x32_bf16 a[240:243], v[128:131], v[116:119], a[240:243]
  ds_read_b64 v[246:247], v64 offset:24576
  ds_read_b128 v[104:107], v62 offset:3136
  v_mfma_f32_16x16x32_bf16 a[244:247], v[132:135], v[116:119], 0
  ds_read_b128 v[108:111], v62 offset:3072
  v_mfma_f32_16x16x32_bf16 a[240:243], v[136:139], v[120:123], a[240:243]
  global_load_lds_dwordx4 v65, s[28:29] offset:3072
  ds_read_b128 v[116:119], v62 offset:3776
  v_mfma_f32_16x16x32_bf16 a[244:247], v[140:143], v[120:123], a[244:247]
  v_mfma_f32_16x16x32_bf16 a[240:243], v[144:147], v[168:171], a[240:243]
  s_waitcnt lgkmcnt(7)
  v_add_f32 v28, v28, v30
  v_mfma_f32_16x16x32_bf16 a[244:247], v[148:151], v[168:171], a[244:247]
  v_add_f32 v32, v32, v34
  v_add_f32 v29, v29, v31
  v_mfma_f32_16x16x32_bf16 a[240:243], v[152:155], v[172:175], a[240:243]
  v_add_f32 v33, v33, v35
  v_cvt_pk_bf16_f32 v12, v28, v32
  v_mfma_f32_16x16x32_bf16 a[244:247], v[156:159], v[172:175], a[244:247]
  v_cvt_pk_bf16_f32 v13, v29, v33
  v_bfi_b32 v12, s25, v16, v12
  v_mfma_f32_16x16x32_bf16 a[244:247], v[160:163], v[84:87], a[244:247]
  s_add_u32 m0, s36, 32768
  v_add_u32 v65, 32768, v65
  global_load_lds_dwordx4 v65, s[28:29] offset:0
  ds_write_b128 v60, a[240:243] offset:4096
  v_mfma_f32_16x16x32_bf16 a[244:247], v[164:167], v[76:79], a[244:247]
  v_bfi_b32 v13, s25, v17, v13
  s_waitcnt lgkmcnt(4)
  v_mfma_f32_16x16x32_bf16 a[244:247], v[212:215], a[200:203], a[244:247]
  v_add_f32 v240, v240, v242
  v_add_f32 v244, v244, v246
  v_mfma_f32_16x16x32_bf16 a[244:247], v[216:219], a[196:199], a[244:247]
  v_add_f32 v241, v241, v243
  v_add_f32 v245, v245, v247
  v_mfma_f32_16x16x32_bf16 a[244:247], v[220:223], a[192:195], a[244:247]
  v_cvt_pk_bf16_f32 v14, v240, v244
  v_cvt_pk_bf16_f32 v15, v241, v245
  v_mfma_f32_16x16x32_bf16 a[244:247], v[232:235], a[208:211], a[244:247]
  v_bfi_b32 v14, s25, v18, v14
  v_bfi_b32 v15, s25, v19, v15
  v_mfma_f32_16x16x32_bf16 a[244:247], v[128:131], v[176:179], a[244:247]
  global_load_lds_dwordx4 v65, s[28:29] offset:1024
  buffer_store_dwordx4 v[12:15], v1, s[40:43], s10 offen sc1
  s_mov_b64 exec, 1
  buffer_store_dwordx4 v[192:195], v1, s[40:43], s12 offen sc1
  s_mov_b64 exec, -1
  s_waitcnt vmcnt(11)
  s_mov_b32 exec_hi, 0
  buffer_store_dword v2, v127, s[40:43], s24 offen sc1
  s_mov_b32 exec_hi, -1
  v_mfma_f32_16x16x32_bf16 a[244:247], v[136:139], v[180:183], a[244:247]
  ds_read_b128 v[120:123], v62 offset:3712
  ds_read_b128 v[168:171], v62 offset:3648
  v_mfma_f32_16x16x32_bf16 a[244:247], v[144:147], v[184:187], a[244:247]
  ds_read_b128 v[172:175], v62 offset:3584
  v_mfma_f32_16x16x32_bf16 a[244:247], v[152:155], v[188:191], a[244:247]
  v_mfma_f32_16x16x32_bf16 v[248:251], v[88:91], v[196:199], 0
  v_mfma_f32_16x16x32_bf16 v[252:255], v[88:91], v[200:203], 0
  v_mfma_f32_16x16x32_bf16 v[240:243], v[80:83], v[204:207], 0
  global_load_lds_dwordx4 v65, s[28:29] offset:2048
  v_mfma_f32_16x16x32_bf16 v[244:247], v[84:87], v[204:207], 0
  v_mfma_f32_16x16x32_bf16 a[248:251], v[132:135], v[176:179], 0
  v_mfma_f32_16x16x32_bf16 a[248:251], v[140:143], v[180:183], a[248:251]
  v_mfma_f32_16x16x32_bf16 a[248:251], v[148:151], v[184:187], a[248:251]
  ds_write_b128 v60, a[244:247] offset:5120
  v_cvt_pk_bf16_f32 v224, v248, v249
  v_mfma_f32_16x16x32_bf16 a[248:251], v[156:159], v[188:191], a[248:251]
  v_cvt_pk_bf16_f32 v225, v250, v251
  v_cvt_pk_bf16_f32 v226, v252, v253
  v_mfma_f32_16x16x32_bf16 v[248:251], v[92:95], v[196:199], 0
  global_load_lds_dwordx4 v65, s[28:29] offset:3072
  v_cvt_pk_bf16_f32 v227, v254, v255
  v_mfma_f32_16x16x32_bf16 v[252:255], v[92:95], v[200:203], 0
  v_cvt_pk_bf16_f32 v236, v240, v241
  v_cvt_pk_bf16_f32 v237, v242, v243
  v_mfma_f32_16x16x32_bf16 a[248:251], v[128:131], v[96:99], a[248:251]
  v_cvt_pk_bf16_f32 v238, v244, v245
  v_cvt_pk_bf16_f32 v239, v246, v247
  v_mfma_f32_16x16x32_bf16 a[252:255], v[132:135], v[96:99], 0
  v_cvt_pk_bf16_f32 v228, v248, v249
  v_cvt_pk_bf16_f32 v229, v250, v251
  v_mfma_f32_16x16x32_bf16 a[248:251], v[136:139], v[100:103], a[248:251]
  v_cvt_pk_bf16_f32 v230, v252, v253
  v_cvt_pk_bf16_f32 v231, v254, v255
  v_mfma_f32_16x16x32_bf16 a[252:255], v[140:143], v[100:103], a[252:255]
  s_waitcnt lgkmcnt(7)
  v_mfma_f32_16x16x32_bf16 a[248:251], v[144:147], v[104:107], a[248:251]
  s_add_u32 m0, s36, 36864
  v_add_u32 v65, 32768, v65
  global_load_lds_dwordx4 v65, s[28:29] offset:0
  v_mfma_f32_16x16x32_bf16 a[252:255], v[148:151], v[104:107], a[252:255]
  s_waitcnt lgkmcnt(6)
  v_mfma_f32_16x16x32_bf16 a[248:251], v[152:155], v[108:111], a[248:251]
  v_mfma_f32_16x16x32_bf16 a[252:255], v[156:159], v[108:111], a[252:255]
  v_mfma_f32_16x16x32_bf16 a[248:251], v[160:163], v[88:91], a[248:251]
  v_mfma_f32_16x16x32_bf16 a[248:251], v[164:167], v[80:83], a[248:251]
  v_mfma_f32_16x16x32_bf16 a[248:251], v[216:219], a[200:203], a[248:251]
  global_load_lds_dwordx4 v65, s[28:29] offset:1024
  v_mfma_f32_16x16x32_bf16 a[248:251], v[220:223], a[196:199], a[248:251]
  v_mfma_f32_16x16x32_bf16 a[248:251], v[224:227], a[192:195], a[248:251]
  v_mfma_f32_16x16x32_bf16 a[248:251], v[232:235], a[212:215], a[248:251]
  v_mfma_f32_16x16x32_bf16 a[248:251], v[236:239], a[204:207], a[248:251]
  s_waitcnt lgkmcnt(5)
  v_mfma_f32_16x16x32_bf16 a[252:255], v[128:131], v[116:119], a[252:255]
  s_waitcnt lgkmcnt(3)
  v_mfma_f32_16x16x32_bf16 a[252:255], v[136:139], v[120:123], a[252:255]
  global_load_lds_dwordx4 v65, s[28:29] offset:2048
  s_waitcnt lgkmcnt(2)
  v_mfma_f32_16x16x32_bf16 a[252:255], v[144:147], v[168:171], a[252:255]
  s_waitcnt lgkmcnt(1)
  v_mfma_f32_16x16x32_bf16 a[252:255], v[152:155], v[172:175], a[252:255]
  ds_write_b128 v60, a[248:251] offset:6144
  v_mfma_f32_16x16x32_bf16 a[252:255], v[160:163], v[92:95], a[252:255]
  v_mfma_f32_16x16x32_bf16 a[252:255], v[164:167], v[84:87], a[252:255]
  v_mfma_f32_16x16x32_bf16 a[252:255], v[220:223], a[200:203], a[252:255]
  v_mfma_f32_16x16x32_bf16 a[252:255], v[224:227], a[196:199], a[252:255]
  v_mfma_f32_16x16x32_bf16 a[252:255], v[228:231], a[192:195], a[252:255]
  v_mfma_f32_16x16x32_bf16 a[252:255], v[232:235], a[216:219], a[252:255]
  v_mfma_f32_16x16x32_bf16 a[252:255], v[236:239], a[208:211], a[252:255]
  s_nop 7
  ds_write_b128 v60, a[252:255] offset:7168
  s_waitcnt lgkmcnt(0)
  s_barrier
  ds_read_b64 v[72:73], v61 offset:4096
  ds_read_b64 v[74:75], v61 offset:12288
  ds_read_b64 v[76:77], v61 offset:20480
  ds_read_b64 v[78:79], v61 offset:28672
  ds_read_b64 v[80:81], v64 offset:4096
  ds_read_b64 v[82:83], v64 offset:12288
  ds_read_b64 v[84:85], v64 offset:20480
  ds_read_b64 v[86:87], v64 offset:28672
  s_waitcnt lgkmcnt(4)
  s_nop 0
  v_pk_add_f32 v[72:73], v[72:73], v[74:75]
  v_pk_add_f32 v[76:77], v[76:77], v[78:79]
  v_cvt_pk_bf16_f32 v12, v72, v76
  v_cvt_pk_bf16_f32 v13, v73, v77
  v_bfi_b32 v12, s25, v16, v12
  v_bfi_b32 v13, s25, v17, v13
  s_waitcnt lgkmcnt(0)
  s_nop 0
  v_pk_add_f32 v[80:81], v[80:81], v[82:83]
  v_pk_add_f32 v[84:85], v[84:85], v[86:87]
  v_cvt_pk_bf16_f32 v14, v80, v84
  v_cvt_pk_bf16_f32 v15, v81, v85
  v_bfi_b32 v14, s25, v18, v14
  v_bfi_b32 v15, s25, v19, v15
  buffer_store_dwordx4 v[12:15], v1, s[40:43], s11 offen sc1
  s_bfe_u32 s1, s44, 0x30002
  s_lshr_b32 s0, s44, 7
  s_lshl3_add_u32 s52, s0, s1
  s_bfe_u32 s0, s44, 65541
  s_and_b32 s1, s52, 15
  s_lshl1_add_u32 s54, s1, s0
  s_bfe_u32 s0, s44, 0x20005
  s_and_b32 s1, s44, 3
  s_lshl2_add_u32 s53, s0, s1
  s_mul_i32 s0, s53, 7
  s_lshr_b32 s0, s0, 2
  v_bfe_u32 v70, v0, 3, 3
  v_min_u32 v70, 2, v70
  v_add_u32 v70, s0, v70
  v_min_u32 v70, 27, v70
  v_and_b32 v71, 7, v0
  v_lshl_add_u32 v70, v70, 5, v71
  s_lshl_b32 s0, s45, 10
  s_add_u32 s0, s0, 786432
  v_lshl_add_u32 v54, v70, 7, s0
  s_mul_i32 s5, s53, 229376
  s_add_u32 s5, s5, s36
  s_add_u32 s5, s5, 10092544
  buffer_load_dword v55, v54, s[40:43], 0 offen sc1
  global_load_lds_dwordx4 v65, s[28:29] offset:3072
  s_add_u32 m0, s36, 65536
  v_add_u32 v65, 32768, v65
  global_load_lds_dwordx4 v65, s[28:29] offset:0
  global_load_lds_dwordx4 v65, s[28:29] offset:1024
  s_waitcnt vmcnt(15)
  s_nop 0
  ds_read_b64_tr_b16 a[0:1], v126 offset:0
  ds_read_b64_tr_b16 a[2:3], v126 offset:4096
  ds_read_b64_tr_b16 a[4:5], v126 offset:512
  ds_read_b64_tr_b16 a[6:7], v126 offset:4608
  global_load_lds_dwordx4 v65, s[28:29] offset:2048
  global_load_lds_dwordx4 v65, s[28:29] offset:3072
  ds_read_b64_tr_b16 a[8:9], v126 offset:1024
  ds_read_b64_tr_b16 a[10:11], v126 offset:5120
  ds_read_b64_tr_b16 a[12:13], v126 offset:1536
  ds_read_b64_tr_b16 a[14:15], v126 offset:5632
  s_add_u32 m0, s36, 69632
  v_add_u32 v65, 32768, v65
  global_load_lds_dwordx4 v65, s[28:29] offset:0
  global_load_lds_dwordx4 v65, s[28:29] offset:1024
  ds_read_b64_tr_b16 a[16:17], v126 offset:2048
  ds_read_b64_tr_b16 a[18:19], v126 offset:6144
  ds_read_b64_tr_b16 a[20:21], v126 offset:2560
  ds_read_b64_tr_b16 a[22:23], v126 offset:6656
  global_load_lds_dwordx4 v65, s[28:29] offset:2048
  global_load_lds_dwordx4 v65, s[28:29] offset:3072
  ds_read_b64_tr_b16 a[24:25], v126 offset:3072
  ds_read_b64_tr_b16 a[26:27], v126 offset:7168
  ds_read_b64_tr_b16 a[28:29], v126 offset:3584
  ds_read_b64_tr_b16 a[30:31], v126 offset:7680
  v_lshlrev_b32 v36, 16, v4
  v_and_b32 v37, s47, v4
  v_lshlrev_b32 v38, 16, v5
  v_and_b32 v39, s47, v5
  v_lshlrev_b32 v40, 16, v6
  v_and_b32 v41, s47, v6
  v_lshlrev_b32 v42, 16, v7
  v_and_b32 v43, s47, v7
  v_lshlrev_b32 v44, 16, v8
  v_and_b32 v45, s47, v8
  v_lshlrev_b32 v46, 16, v9
  v_and_b32 v47, s47, v9
  v_lshlrev_b32 v48, 16, v10
  v_and_b32 v49, s47, v10
  v_lshlrev_b32 v50, 16, v11
  v_and_b32 v51, s47, v11
  v_and_b32 v68, 0xfc, v0
  v_and_b32 v70, 0x30, v1
  s_movk_i32 s58, 8448
  v_mad_u32_u24 v28, v68, s58, v70
  s_lshr_b32 s58, s44, 1
  s_lshl_b32 s58, s58, 6
  s_add_u32 s58, s58, 3670016
  s_add_u32 s59, s58, 8448
  s_add_u32 s60, s58, 16896
  s_add_u32 s61, s58, 25344
  s_lshl_b32 s66, s45, 10
  s_add_u32 s66, s66, 32768
  s_bitcmp1_b32 s44, 0
  s_cselect_b32 s49, 0x04040000, 0
  s_add_u32 s50, s49, 0x03020c0c
  s_add_u32 s49, s49, 0x01000c0c
  s_mov_b32 s68, 0x5f800000
  v_lshrrev_b32 v68, 3, v0
  v_and_b32 v69, 0x70, v1
  v_lshl_add_u32 v29, v68, 10, v69
  s_lshr_b32 s62, s44, 2
  s_lshl_b32 s62, s62, 7
  s_and_b32 s63, s44, 3
  s_add_u32 s62, s62, s63
  s_lshl_b32 s62, s62, 8
  s_add_u32 s62, s62, 5898240
  s_mov_b32 s63, 7995392
  v_mov_b32 v30, s47
  s_lshl2_add_u32 s0, s52, s45
  s_lshl_b32 s16, s0, 15
  s_add_u32 s16, s16, 5898240
  s_lshl4_add_u32 s0, s0, s53
  s_mul_i32 s0, s0, 7168
  s_add_u32 s12, s0, 13762560
  s_add_u32 s13, s0, 13766656
  s_sub_u32 s14, s24, 524288
  s_lshl3_add_u32 s0, s54, s45
  s_mul_i32 s0, s0, 28672
  s_add_u32 s9, s0, 13762560
  s_waitcnt vmcnt(10)
  buffer_load_dwordx4 v[72:75], v28, s[40:43], s58 offen sc1
  buffer_load_dwordx4 v[76:79], v28, s[40:43], s59 offen sc1
  buffer_load_dwordx4 v[80:83], v28, s[40:43], s60 offen sc1
  buffer_load_dwordx4 v[84:87], v28, s[40:43], s61 offen sc1
  buffer_load_dwordx4 v[32:35], v1, s[40:43], s66 offen sc1
  s_waitcnt vmcnt(14)
chk_1:
  v_cmp_ne_u32_e64 vcc, v55, v2
  s_cmp_lg_u64 vcc, 0
  s_cbranch_scc1 retry_2
  s_waitcnt vmcnt(13)
  ds_read_b64_tr_b16 a[32:33], v126 offset:32768
  ds_read_b64_tr_b16 a[34:35], v126 offset:36864
  ds_read_b64_tr_b16 a[36:37], v126 offset:33280
  ds_read_b64_tr_b16 a[38:39], v126 offset:37376
  ds_read_b64_tr_b16 a[40:41], v126 offset:33792
  ds_read_b64_tr_b16 a[42:43], v126 offset:37888
  ds_read_b64_tr_b16 a[44:45], v126 offset:34304
  ds_read_b64_tr_b16 a[46:47], v126 offset:38400
  ds_read_b64_tr_b16 a[48:49], v126 offset:34816
  ds_read_b64_tr_b16 a[50:51], v126 offset:38912
  ds_read_b64_tr_b16 a[52:53], v126 offset:35328
  ds_read_b64_tr_b16 a[54:55], v126 offset:39424
  ds_read_b64_tr_b16 a[56:57], v126 offset:35840
  ds_read_b64_tr_b16 a[58:59], v126 offset:39936
  ds_read_b64_tr_b16 a[60:61], v126 offset:36352
  ds_read_b64_tr_b16 a[62:63], v126 offset:40448
  s_waitcnt lgkmcnt(14)
  s_add_u32 m0, s36, 0
  s_add_u32 s6, s5, 0
  s_nop 0
  buffer_load_dwordx4 v1, s[40:43], s6 offen offset:0 sc1 lds
  buffer_load_dwordx4 v1, s[40:43], s6 offen offset:1024 sc1 lds
  buffer_load_dwordx4 v1, s[40:43], s6 offen offset:2048 sc1 lds
  buffer_load_dwordx4 v1, s[40:43], s6 offen offset:3072 sc1 lds
  s_add_u32 m0, s36, 4096
  s_add_u32 s6, s5, 4096
  buffer_load_dwordx4 v1, s[40:43], s6 offen offset:0 sc1 lds
  v_lshrrev_b32 v66, 3, v69
  v_alignbit_b32 v66, v2, v2, v66
  v_alignbit_b32 v67, v66, v66, 1
  v_and_b32 v66, s25, v66
  v_and_b32 v67, s25, v67
  v_bfe_u32 v68, v0, 2, 3
  v_bfe_u32 v71, v0, 5, 1
  v_lshl_add_u32 v70, v71, 6, v70
  v_lshl_add_u32 v25, v68, 7, v70
  v_lshrrev_b32 v14, 3, v70
  v_alignbit_b32 v14, v2, v2, v14
  v_alignbit_b32 v15, v14, v14, 1
  v_and_b32 v14, s25, v14
  v_and_b32 v15, s25, v15
  v_add_u32 v26, 65536, v1
  v_add_u32 v27, 131072, v1
  v_add_u32 v21, 114688, v1
  v_mov_b32 v53, 0x383ef424
  s_mov_b32 s30, 0xc09d30fc
  s_mov_b32 s31, 0x5e60ec05
  s_mov_b32 s69, 0x3eeff558
  v_bfe_u32 v68, v0, 3, 2
  v_lshl_add_u32 v68, v68, 1, v71
  v_lshl_add_u32 v68, v68, 10, v69
  s_lshl3_add_u32 s0, s54, s45
  s_lshl_b32 s0, s0, 6
  s_add_u32 s0, s0, s55
  s_lshl_b32 s0, s0, 7
  v_add_u32 v22, s0, v68
  s_waitcnt vmcnt(10)
  ds_read_b64_tr_b16 a[64:65], v125 offset:0
  ds_read_b64_tr_b16 a[66:67], v125 offset:4096
  ds_read_b64_tr_b16 a[68:69], v125 offset:512
  ds_read_b64_tr_b16 a[70:71], v125 offset:4608
  ds_read_b64_tr_b16 a[72:73], v125 offset:1024
  ds_read_b64_tr_b16 a[74:75], v125 offset:5120
  ds_read_b64_tr_b16 a[76:77], v125 offset:1536
  ds_read_b64_tr_b16 a[78:79], v125 offset:5632
  ds_read_b64_tr_b16 a[80:81], v125 offset:2048
  ds_read_b64_tr_b16 a[82:83], v125 offset:6144
  ds_read_b64_tr_b16 a[84:85], v125 offset:2560
  ds_read_b64_tr_b16 a[86:87], v125 offset:6656
  ds_read_b64_tr_b16 a[88:89], v125 offset:3072
  ds_read_b64_tr_b16 a[90:91], v125 offset:7168
  ds_read_b64_tr_b16 a[92:93], v125 offset:3584
  ds_read_b64_tr_b16 a[94:95], v125 offset:7680
  s_waitcnt vmcnt(5)
L_zchk:
  v_xor_b32 v144, v72, v16
  v_xor_b32 v145, v73, v17
  v_xor_b32 v146, v74, v18
  v_xor_b32 v147, v75, v19
  v_xor_b32 v148, v76, v16
  v_xor_b32 v149, v77, v17
  v_xor_b32 v150, v78, v18
  v_xor_b32 v151, v79, v19
  v_xor_b32 v152, v80, v16
  v_xor_b32 v153, v81, v17
  v_xor_b32 v154, v82, v18
  v_xor_b32 v155, v83, v19
  v_xor_b32 v156, v84, v16
  v_xor_b32 v157, v85, v17
  v_xor_b32 v158, v86, v18
  v_xor_b32_e64 v159, v87, v19
  v_cmp_ne_u32 s[56:57], v35, v2
  v_or3_b32 v160, v144, v145, v146
  v_or3_b32 v161, v147, v148, v149
  v_or3_b32 v162, v150, v151, v152
  v_or3_b32 v163, v153, v154, v155
  v_or3_b32 v164, v156, v157, v158
  v_or3_b32 v160, v160, v161, v162
  v_or3_b32 v163, v163, v164, v159
  v_bitop3_b32 v160, v160, v163, s25 bitop3:0xa8
  v_cmp_ne_u32_e64 vcc, 0, v160
  s_or_b64 s[56:57], s[56:57], vcc
  s_cbranch_scc1 L_zretry
  buffer_load_dwordx4 v1, s[40:43], s6 offen offset:1024 sc1 lds
  v_perm_b32 v88, v146, v144, s49
  v_perm_b32 v89, v146, v144, s50
  v_perm_b32 v96, v147, v145, s49
  v_perm_b32 v97, v147, v145, s50
  v_pk_fma_f32 v[36:37], v[88:89], s[68:69], v[36:37] op_sel_hi:[1,0,1]
  v_pk_fma_f32 v[44:45], v[96:97], s[68:69], v[44:45] op_sel_hi:[1,0,1]
  v_cvt_pk_bf16_f32 v4, v36, v37
  v_cvt_pk_bf16_f32 v8, v44, v45
  buffer_load_dwordx4 v1, s[40:43], s6 offen offset:2048 sc1 lds
  v_perm_b32 v90, v150, v148, s49
  v_perm_b32 v91, v150, v148, s50
  v_perm_b32 v98, v151, v149, s49
  v_perm_b32 v99, v151, v149, s50
  v_pk_fma_f32 v[38:39], v[90:91], s[68:69], v[38:39] op_sel_hi:[1,0,1]
  v_pk_fma_f32 v[46:47], v[98:99], s[68:69], v[46:47] op_sel_hi:[1,0,1]
  v_cvt_pk_bf16_f32 v5, v38, v39
  v_cvt_pk_bf16_f32 v9, v46, v47
  buffer_load_dwordx4 v1, s[40:43], s6 offen offset:3072 sc1 lds
  v_perm_b32 v92, v154, v152, s49
  v_perm_b32 v93, v154, v152, s50
  v_perm_b32 v100, v155, v153, s49
  v_perm_b32 v101, v155, v153, s50
  v_pk_fma_f32 v[40:41], v[92:93], s[68:69], v[40:41] op_sel_hi:[1,0,1]
  v_pk_fma_f32 v[48:49], v[100:101], s[68:69], v[48:49] op_sel_hi:[1,0,1]
  v_cvt_pk_bf16_f32 v6, v40, v41
  v_cvt_pk_bf16_f32 v10, v48, v49
  s_waitcnt lgkmcnt(14)
  s_nop 0
  s_add_u32 m0, s36, 32768
  s_add_u32 s6, s5, 32768
  buffer_load_dwordx4 v1, s[40:43], s6 offen offset:0 sc1 lds
  v_perm_b32 v94, v158, v156, s49
  v_perm_b32 v95, v158, v156, s50
  v_perm_b32 v102, v159, v157, s49
  v_perm_b32 v103, v159, v157, s50
  v_pk_fma_f32 v[42:43], v[94:95], s[68:69], v[42:43] op_sel_hi:[1,0,1]
  v_pk_fma_f32 v[50:51], v[102:103], s[68:69], v[50:51] op_sel_hi:[1,0,1]
  v_cvt_pk_bf16_f32 v7, v42, v43
  v_cvt_pk_bf16_f32 v11, v50, v51
  v_dot2_f32_bf16 v68, v4, s51, 0
  v_dot2_f32_bf16 v69, v8, s51, 0
  v_dot2_f32_bf16 v70, v4, v4, 0
  v_dot2_f32_bf16 v71, v8, v8, 0
  v_dot2_f32_bf16 v68, v5, s51, v68
  v_dot2_f32_bf16 v69, v9, s51, v69
  v_dot2_f32_bf16 v70, v5, v5, v70
  v_dot2_f32_bf16 v71, v9, v9, v71
  v_dot2_f32_bf16 v68, v6, s51, v68
  v_dot2_f32_bf16 v69, v10, s51, v69
  v_dot2_f32_bf16 v70, v6, v6, v70
  v_dot2_f32_bf16 v71, v10, v10, v71
  v_dot2_f32_bf16 v68, v7, s51, v68
  v_dot2_f32_bf16 v69, v11, s51, v69
  v_dot2_f32_bf16 v70, v7, v7, v70
  v_dot2_f32_bf16 v71, v11, v11, v71
  v_lshlrev_b32 v36, 16, v4
  v_and_b32 v37, s47, v4
  v_permlane32_swap_b32 v68, v69
  v_permlane32_swap_b32 v70, v71
  v_add_f32 v68, v68, v69
  v_add_f32 v70, v70, v71
  v_lshlrev_b32 v38, 16, v5
  v_and_b32 v39, s47, v5
  v_permlane16_swap_b32 v68, v70
  v_add_f32 v68, v68, v70
  v_lshlrev_b32 v40, 16, v6
  v_and_b32 v41, s47, v6
  v_add_f32_dpp v68, v68, v68 row_ror:4 row_mask:0xf bank_mask:0xf
  v_lshlrev_b32 v42, 16, v7
  v_and_b32 v43, s47, v7
  v_add_f32_dpp v68, v68, v68 row_ror:8 row_mask:0xf bank_mask:0xf
  ds_write_b32 v112, v68
  buffer_load_dwordx4 v1, s[40:43], s6 offen offset:1024 sc1 lds
  buffer_load_dwordx4 v1, s[40:43], s6 offen offset:2048 sc1 lds
  v_lshlrev_b32 v44, 16, v8
  v_and_b32 v45, s47, v8
  v_lshlrev_b32 v46, 16, v9
  v_and_b32 v47, s47, v9
  v_lshlrev_b32 v48, 16, v10
  v_and_b32 v49, s47, v10
  v_lshlrev_b32 v50, 16, v11
  v_and_b32 v51, s47, v11
  s_waitcnt lgkmcnt(0)
  s_barrier
  ds_read_b128 v[128:131], v113 offset:0
  ds_read_b128 v[132:135], v113 offset:16
  ds_read_b128 v[136:139], v113 offset:32
  ds_read_b128 v[140:143], v113 offset:48
  buffer_load_dwordx4 v1, s[40:43], s6 offen offset:3072 sc1 lds
  v_cvt_f32_bf16_dpp v88, v32 quad_perm:[0,0,0,0] row_mask:0xf bank_mask:0xf
  v_and_b32_dpp v89, v32, v30 quad_perm:[0,0,0,0] row_mask:0xf bank_mask:0xf
  v_cvt_f32_bf16_dpp v96, v33 quad_perm:[0,0,0,0] row_mask:0xf bank_mask:0xf
  v_and_b32_dpp v97, v33, v30 quad_perm:[0,0,0,0] row_mask:0xf bank_mask:0xf
  s_add_u32 m0, s36, 36864
  s_add_u32 s6, s5, 36864
  buffer_load_dwordx4 v1, s[40:43], s6 offen offset:0 sc1 lds
  v_cvt_f32_bf16_dpp v90, v32 quad_perm:[1,1,1,1] row_mask:0xf bank_mask:0xf
  v_and_b32_dpp v91, v32, v30 quad_perm:[1,1,1,1] row_mask:0xf bank_mask:0xf
  v_cvt_f32_bf16_dpp v98, v33 quad_perm:[1,1,1,1] row_mask:0xf bank_mask:0xf
  v_and_b32_dpp v99, v33, v30 quad_perm:[1,1,1,1] row_mask:0xf bank_mask:0xf
  buffer_load_dwordx4 v1, s[40:43], s6 offen offset:1024 sc1 lds
  v_cvt_f32_bf16_dpp v92, v32 quad_perm:[2,2,2,2] row_mask:0xf bank_mask:0xf
  v_and_b32_dpp v93, v32, v30 quad_perm:[2,2,2,2] row_mask:0xf bank_mask:0xf
  v_cvt_f32_bf16_dpp v100, v33 quad_perm:[2,2,2,2] row_mask:0xf bank_mask:0xf
  v_and_b32_dpp v101, v33, v30 quad_perm:[2,2,2,2] row_mask:0xf bank_mask:0xf
  buffer_load_dwordx4 v1, s[40:43], s6 offen offset:2048 sc1 lds
  v_cvt_f32_bf16_dpp v94, v32 quad_perm:[3,3,3,3] row_mask:0xf bank_mask:0xf
  v_and_b32_dpp v95, v32, v30 quad_perm:[3,3,3,3] row_mask:0xf bank_mask:0xf
  v_cvt_f32_bf16_dpp v102, v33 quad_perm:[3,3,3,3] row_mask:0xf bank_mask:0xf
  v_and_b32_dpp v103, v33, v30 quad_perm:[3,3,3,3] row_mask:0xf bank_mask:0xf
  v_pk_mul_f32 v[96:97], v[96:97], s[68:69] op_sel:[0,1] op_sel_hi:[1,1]
  v_pk_mul_f32 v[98:99], v[98:99], s[68:69] op_sel:[0,1] op_sel_hi:[1,1]
  v_pk_mul_f32 v[100:101], v[100:101], s[68:69] op_sel:[0,1] op_sel_hi:[1,1]
  v_pk_mul_f32 v[102:103], v[102:103], s[68:69] op_sel:[0,1] op_sel_hi:[1,1]
  s_waitcnt lgkmcnt(0)
  s_nop 0
  v_pk_add_f32 v[128:129], v[128:129], v[132:133]
  v_pk_add_f32 v[130:131], v[130:131], v[134:135]
  v_pk_add_f32 v[136:137], v[136:137], v[140:141]
  v_pk_add_f32 v[138:139], v[138:139], v[142:143]
  v_pk_add_f32 v[128:129], v[128:129], v[136:137]
  v_pk_add_f32 v[130:131], v[130:131], v[138:139]
  v_pk_mul_f32 v[132:133], v[128:129], v[52:53] op_sel_hi:[1,0]
  v_pk_mul_f32 v[134:135], v[130:131], v[52:53] op_sel_hi:[1,0]
  v_fma_f32 v133, -v132, v132, v133
  v_fma_f32 v135, -v134, v134, v135
  v_max_f32 v133, 0, v133
  v_max_f32 v135, 0, v135
  v_fmamk_f32 v133, v133, 0x4091afa4, v53
  v_fmamk_f32 v135, v135, 0x4091afa4, v53
  v_rsq_f32 v128, v133
  v_rsq_f32 v130, v135
  v_mul_f32 v129, -v132, v128
  v_mul_f32 v131, -v134, v130
  v_pk_fma_f32 v[36:37], v[36:37], v[128:129], v[128:129] op_sel:[0,0,1] op_sel_hi:[1,0,1]
  v_pk_fma_f32 v[38:39], v[38:39], v[128:129], v[128:129] op_sel:[0,0,1] op_sel_hi:[1,0,1]
  v_pk_fma_f32 v[40:41], v[40:41], v[128:129], v[128:129] op_sel:[0,0,1] op_sel_hi:[1,0,1]
  v_pk_fma_f32 v[42:43], v[42:43], v[128:129], v[128:129] op_sel:[0,0,1] op_sel_hi:[1,0,1]
  v_pk_fma_f32 v[36:37], v[36:37], v[88:89], v[96:97]
  v_pk_fma_f32 v[38:39], v[38:39], v[90:91], v[98:99]
  v_pk_fma_f32 v[40:41], v[40:41], v[92:93], v[100:101]
  v_pk_fma_f32 v[42:43], v[42:43], v[94:95], v[102:103]
  v_cvt_pk_bf16_f32 v104, v36, v37
  v_cvt_pk_bf16_f32 v105, v38, v39
  v_cvt_pk_bf16_f32 v106, v40, v41
  v_cvt_pk_bf16_f32 v107, v42, v43
  v_bfi_b32 v104, s25, v66, v104
  v_bfi_b32 v105, s25, v67, v105
  buffer_store_dwordx4 v[104:107], v29, s[40:43], s62 offen offset:0 sc1
  v_pk_fma_f32 v[44:45], v[44:45], v[130:131], v[130:131] op_sel:[0,0,1] op_sel_hi:[1,0,1]
  v_pk_fma_f32 v[46:47], v[46:47], v[130:131], v[130:131] op_sel:[0,0,1] op_sel_hi:[1,0,1]
  v_pk_fma_f32 v[48:49], v[48:49], v[130:131], v[130:131] op_sel:[0,0,1] op_sel_hi:[1,0,1]
  v_pk_fma_f32 v[50:51], v[50:51], v[130:131], v[130:131] op_sel:[0,0,1] op_sel_hi:[1,0,1]
  v_pk_fma_f32 v[44:45], v[44:45], v[88:89], v[96:97]
  v_pk_fma_f32 v[46:47], v[46:47], v[90:91], v[98:99]
  v_pk_fma_f32 v[48:49], v[48:49], v[92:93], v[100:101]
  v_pk_fma_f32 v[50:51], v[50:51], v[94:95], v[102:103]
  v_cvt_pk_bf16_f32 v108, v44, v45
  v_cvt_pk_bf16_f32 v109, v46, v47
  v_cvt_pk_bf16_f32 v110, v48, v49
  v_cvt_pk_bf16_f32 v111, v50, v51
  v_bfi_b32 v108, s25, v66, v108
  v_bfi_b32 v109, s25, v67, v109
  buffer_store_dwordx4 v[108:111], v29, s[40:43], s62 offen offset:128 sc1
  v_mov_b32 v12, v34
  buffer_load_dwordx4 v1, s[40:43], s6 offen offset:3072 sc1 lds
  s_waitcnt lgkmcnt(5)
  s_add_u32 m0, s36, 65536
  s_add_u32 s6, s5, 65536
  buffer_load_dwordx4 v1, s[40:43], s6 offen offset:0 sc1 lds
  buffer_load_dwordx4 v1, s[40:43], s6 offen offset:1024 sc1 lds
  buffer_load_dwordx4 v1, s[40:43], s6 offen offset:2048 sc1 lds
  buffer_load_dwordx4 v1, s[40:43], s6 offen offset:3072 sc1 lds
  s_add_u32 m0, s36, 69632
  s_add_u32 s6, s5, 69632
  buffer_load_dwordx4 v1, s[40:43], s6 offen offset:0 sc1 lds
  buffer_load_dwordx4 v1, s[40:43], s6 offen offset:1024 sc1 lds
  buffer_load_dwordx4 v1, s[40:43], s6 offen offset:2048 sc1 lds
  buffer_load_dwordx4 v1, s[40:43], s6 offen offset:3072 sc1 lds
  s_add_u32 m0, s36, 98304
  v_add_u32 v65, 32768, v65
  global_load_lds_dwordx4 v65, s[28:29] offset:0
  global_load_lds_dwordx4 v65, s[28:29] offset:1024
  global_load_lds_dwordx4 v65, s[28:29] offset:2048
  global_load_lds_dwordx4 v65, s[28:29] offset:3072
  s_add_u32 m0, s36, 102400
  v_add_u32 v65, 32768, v65
  global_load_lds_dwordx4 v65, s[28:29] offset:0
  global_load_lds_dwordx4 v65, s[28:29] offset:1024
  global_load_lds_dwordx4 v65, s[28:29] offset:2048
  global_load_lds_dwordx4 v65, s[28:29] offset:3072
  s_waitcnt vmcnt(17)
  s_add_u32 s68, s16, 0
  s_add_u32 s69, s16, 4096
  s_add_u32 s70, s16, 8192
  s_add_u32 s71, s16, 12288
  s_add_u32 s72, s16, 16384
  s_add_u32 s73, s16, 20480
  s_add_u32 s74, s16, 24576
  s_add_u32 s75, s16, 28672
  buffer_load_dwordx4 v[128:131], v25, s[40:43], s68 offen offset:0 sc1
  buffer_load_dwordx4 v[132:135], v25, s[40:43], s70 offen offset:0 sc1
  buffer_load_dwordx4 v[136:139], v25, s[40:43], s72 offen offset:0 sc1
  buffer_load_dwordx4 v[140:143], v25, s[40:43], s74 offen offset:0 sc1
  buffer_load_dwordx4 v[144:147], v25, s[40:43], s68 offen offset:1024 sc1
  buffer_load_dwordx4 v[148:151], v25, s[40:43], s70 offen offset:1024 sc1
  buffer_load_dwordx4 v[152:155], v25, s[40:43], s72 offen offset:1024 sc1
  buffer_load_dwordx4 v[156:159], v25, s[40:43], s74 offen offset:1024 sc1
  buffer_load_dwordx4 v[160:163], v25, s[40:43], s68 offen offset:2048 sc1
  buffer_load_dwordx4 v[164:167], v25, s[40:43], s70 offen offset:2048 sc1
  buffer_load_dwordx4 v[168:171], v25, s[40:43], s72 offen offset:2048 sc1
  s_add_u32 s76, s9, 0
  s_nop 0
  s_add_u32 s77, s9, 4096
  s_add_u32 s78, s9, 7168
  s_add_u32 s79, s9, 11264
  s_add_u32 s80, s9, 14336
  s_add_u32 s81, s9, 18432
  s_add_u32 s32, s9, 21504
  s_add_u32 s33, s9, 25600
  v_mov_b32 v124, v65
  v_mov_b32 v20, v66
  v_mov_b32 v23, v67
  v_and_b32 v24, 7, v0
  s_lshr_b32 s0, s55, 1
  s_lshl_b32 s1, s54, 5
  s_add_u32 s0, s0, s1
  s_lshl_b32 s0, s0, 7
  s_add_u32 s0, s0, 262144
  v_lshl_add_u32 v24, v24, 9, s0
  s_waitcnt vmcnt(19) lgkmcnt(0)
  s_barrier
  ds_read_b128 v[92:95], v1 offset:0
  ds_read_b128 v[96:99], v1 offset:32768
  ds_read_b128 v[100:103], v1 offset:8192
  ds_read_b128 v[104:107], v1 offset:40960
  ds_read_b128 v[108:111], v26 offset:0
  ds_read_b128 v[112:115], v1 offset:16384
  s_waitcnt vmcnt(9)
  v_xor_b32 v128, v128, v14
  v_xor_b32 v129, v129, v15
  v_xor_b32 v132, v132, v14
  v_xor_b32 v133, v133, v15
  v_or3_b32 v13, v128, v129, v132
  v_bitop3_b32 v13, v13, v133, s25 bitop3:0xa8
  v_cmp_ne_u32 vcc, 0, v13
  s_cbranch_vccnz xr_4
xd_5:
  s_waitcnt lgkmcnt(2)
  v_mfma_f32_32x32x16_bf16 v[28:43], v[92:95], v[128:131], 0
  ds_read_b128 v[116:119], v1 offset:49152
  buffer_load_dwordx4 v[172:175], v25, s[40:43], s74 offen offset:2048 sc1
  s_waitcnt vmcnt(12)
  ds_read_b64_tr_b16 a[96:97], v125 offset:32768
  ds_read_b64_tr_b16 a[98:99], v125 offset:36864
  v_mfma_f32_32x32x16_bf16 v[44:59], v[96:99], v[128:131], 0
  ds_read_b128 v[92:95], v1 offset:24576
  s_waitcnt vmcnt(8)
  v_xor_b32 v136, v136, v14
  v_xor_b32 v137, v137, v15
  v_xor_b32 v140, v140, v14
  ds_read_b64_tr_b16 a[100:101], v125 offset:33280
  ds_read_b64_tr_b16 a[102:103], v125 offset:37376
  v_mfma_f32_32x32x16_bf16 v[28:43], v[100:103], v[132:135], v[28:43]
  ds_read_b128 v[96:99], v1 offset:57344
  v_xor_b32 v141, v141, v15
  v_or3_b32 v13, v136, v137, v140
  v_bitop3_b32 v13, v13, v141, s25 bitop3:0xa8
  buffer_load_dwordx4 v[176:179], v25, s[40:43], s68 offen offset:3072 sc1
  ds_read_b64_tr_b16 a[104:105], v125 offset:33792
  ds_read_b64_tr_b16 a[106:107], v125 offset:37888
  v_mfma_f32_32x32x16_bf16 v[44:59], v[104:107], v[132:135], v[44:59]
  ds_read_b128 v[100:103], v26 offset:8192
  v_cmp_ne_u32 vcc, 0, v13
  ds_read_b64_tr_b16 a[108:109], v125 offset:34304
  ds_read_b64_tr_b16 a[110:111], v125 offset:38400
  s_waitcnt lgkmcnt(8)
  v_mfma_f32_32x32x16_bf16 v[60:75], v[108:111], v[128:131], 0
  ds_read_b128 v[104:107], v1 offset:1024
  ds_read_b64_tr_b16 a[112:113], v125 offset:34816
  ds_read_b64_tr_b16 a[114:115], v125 offset:38912
  s_cbranch_vccnz xr_7
xd_8:
  v_mfma_f32_32x32x16_bf16 v[28:43], v[112:115], v[136:139], v[28:43]
  ds_read_b128 v[108:111], v1 offset:33792
  buffer_load_dwordx4 v[180:183], v25, s[40:43], s70 offen offset:3072 sc1
  ds_read_b64_tr_b16 a[116:117], v125 offset:35328
  ds_read_b64_tr_b16 a[118:119], v125 offset:39424
  v_mfma_f32_32x32x16_bf16 v[44:59], v[116:119], v[136:139], v[44:59]
  ds_read_b128 v[112:115], v1 offset:9216
  s_waitcnt vmcnt(8)
  v_xor_b32 v144, v144, v14
  v_xor_b32 v145, v145, v15
  v_xor_b32 v148, v148, v14
  ds_read_b64_tr_b16 a[120:121], v125 offset:35840
  ds_read_b64_tr_b16 a[122:123], v125 offset:39936
  v_mfma_f32_32x32x16_bf16 v[28:43], v[92:95], v[140:143], v[28:43]
  ds_read_b128 v[116:119], v1 offset:41984
  v_xor_b32 v149, v149, v15
  v_or3_b32 v13, v144, v145, v148
  v_bitop3_b32 v13, v13, v149, s25 bitop3:0xa8
  buffer_load_dwordx4 v[184:187], v25, s[40:43], s72 offen offset:3072 sc1
  ds_read_b64_tr_b16 a[124:125], v125 offset:36352
  ds_read_b64_tr_b16 a[126:127], v125 offset:40448
  s_waitcnt lgkmcnt(8)
  v_mfma_f32_32x32x16_bf16 v[44:59], v[96:99], v[140:143], v[44:59]
  ds_read_b128 v[92:95], v26 offset:16384
  v_cmp_ne_u32 vcc, 0, v13
  v_mfma_f32_32x32x16_bf16 v[60:75], v[100:103], v[132:135], v[60:75]
  ds_read_b128 v[96:99], v1 offset:17408
  s_cbranch_vccnz xr_10
xd_11:
  v_mfma_f32_32x32x16_bf16 v[28:43], v[104:107], v[144:147], v[28:43]
  ds_read_b128 v[100:103], v1 offset:50176
  buffer_load_dwordx4 v[188:191], v25, s[40:43], s74 offen offset:3072 sc1
  v_mfma_f32_32x32x16_bf16 v[44:59], v[108:111], v[144:147], v[44:59]
  ds_read_b128 v[104:107], v1 offset:25600
  s_waitcnt vmcnt(8)
  v_xor_b32 v152, v152, v14
  v_xor_b32 v153, v153, v15
  v_xor_b32 v156, v156, v14
  s_waitcnt lgkmcnt(2)
  v_mfma_f32_32x32x16_bf16 v[28:43], v[112:115], v[148:151], v[28:43]
  ds_read_b128 v[108:111], v1 offset:58368
  v_xor_b32 v157, v157, v15
  v_or3_b32 v13, v152, v153, v156
  v_bitop3_b32 v13, v13, v157, s25 bitop3:0xa8
  buffer_load_dwordx4 v[192:195], v25, s[40:43], s69 offen offset:0 sc1
  v_mfma_f32_32x32x16_bf16 v[44:59], v[116:119], v[148:151], v[44:59]
  ds_read_b128 v[112:115], v26 offset:24576
  v_cmp_ne_u32 vcc, 0, v13
  v_mfma_f32_32x32x16_bf16 v[60:75], v[92:95], v[136:139], v[60:75]
  ds_read_b128 v[116:119], v1 offset:2048
  s_cbranch_vccnz xr_13
xd_14:
  v_mfma_f32_32x32x16_bf16 v[28:43], v[96:99], v[152:155], v[28:43]
  ds_read_b128 v[92:95], v1 offset:34816
  buffer_load_dwordx4 v[196:199], v25, s[40:43], s71 offen offset:0 sc1
  s_waitcnt lgkmcnt(2)
  v_mfma_f32_32x32x16_bf16 v[44:59], v[100:103], v[152:155], v[44:59]
  ds_read_b128 v[96:99], v1 offset:10240
  s_waitcnt vmcnt(8)
  v_xor_b32 v160, v160, v14
  v_xor_b32 v161, v161, v15
  v_xor_b32 v164, v164, v14
  v_mfma_f32_32x32x16_bf16 v[28:43], v[104:107], v[156:159], v[28:43]
  ds_read_b128 v[100:103], v1 offset:43008
  v_xor_b32 v165, v165, v15
  v_or3_b32 v13, v160, v161, v164
  v_bitop3_b32 v13, v13, v165, s25 bitop3:0xa8
  buffer_load_dwordx4 v[200:203], v25, s[40:43], s73 offen offset:0 sc1
  v_mfma_f32_32x32x16_bf16 v[44:59], v[108:111], v[156:159], v[44:59]
  ds_read_b128 v[104:107], v26 offset:1024
  v_cmp_ne_u32 vcc, 0, v13
  v_mfma_f32_32x32x16_bf16 v[60:75], v[112:115], v[140:143], v[60:75]
  ds_read_b128 v[108:111], v1 offset:18432
  s_cbranch_vccnz xr_16
xd_17:
  s_waitcnt lgkmcnt(2)
  v_mfma_f32_32x32x16_bf16 v[28:43], v[116:119], v[160:163], v[28:43]
  ds_read_b128 v[112:115], v1 offset:51200
  buffer_load_dwordx4 v[204:207], v25, s[40:43], s75 offen offset:0 sc1
  v_mfma_f32_32x32x16_bf16 v[44:59], v[92:95], v[160:163], v[44:59]
  ds_read_b128 v[116:119], v1 offset:26624
  s_waitcnt vmcnt(8)
  v_xor_b32 v168, v168, v14
  v_xor_b32 v169, v169, v15
  v_xor_b32 v172, v172, v14
  v_mfma_f32_32x32x16_bf16 v[28:43], v[96:99], v[164:167], v[28:43]
  ds_read_b128 v[92:95], v1 offset:59392
  v_xor_b32 v173, v173, v15
  v_or3_b32 v13, v168, v169, v172
  v_bitop3_b32 v13, v13, v173, s25 bitop3:0xa8
  buffer_load_dwordx4 v[208:211], v25, s[40:43], s69 offen offset:1024 sc1
  v_mfma_f32_32x32x16_bf16 v[44:59], v[100:103], v[164:167], v[44:59]
  ds_read_b128 v[96:99], v26 offset:9216
  v_cmp_ne_u32 vcc, 0, v13
  s_waitcnt lgkmcnt(2)
  v_mfma_f32_32x32x16_bf16 v[60:75], v[104:107], v[144:147], v[60:75]
  ds_read_b128 v[100:103], v1 offset:3072
  s_cbranch_vccnz xr_19
xd_20:
  v_mfma_f32_32x32x16_bf16 v[28:43], v[108:111], v[168:171], v[28:43]
  ds_read_b128 v[104:107], v1 offset:35840
  buffer_load_dwordx4 v[212:215], v25, s[40:43], s71 offen offset:1024 sc1
  v_mfma_f32_32x32x16_bf16 v[44:59], v[112:115], v[168:171], v[44:59]
  ds_read_b128 v[108:111], v1 offset:11264
  s_waitcnt vmcnt(8)
  v_xor_b32 v176, v176, v14
  v_xor_b32 v177, v177, v15
  v_xor_b32 v180, v180, v14
  v_mfma_f32_32x32x16_bf16 v[28:43], v[116:119], v[172:175], v[28:43]
  ds_read_b128 v[112:115], v1 offset:44032
  v_xor_b32 v181, v181, v15
  v_or3_b32 v13, v176, v177, v180
  v_bitop3_b32 v13, v13, v181, s25 bitop3:0xa8
  buffer_load_dwordx4 v[216:219], v25, s[40:43], s73 offen offset:1024 sc1
  s_waitcnt lgkmcnt(2)
  v_mfma_f32_32x32x16_bf16 v[44:59], v[92:95], v[172:175], v[44:59]
  ds_read_b128 v[116:119], v26 offset:17408
  v_cmp_ne_u32 vcc, 0, v13
  v_mfma_f32_32x32x16_bf16 v[60:75], v[96:99], v[148:151], v[60:75]
  ds_read_b128 v[92:95], v1 offset:19456
  s_cbranch_vccnz xr_22
xd_23:
  v_mfma_f32_32x32x16_bf16 v[28:43], v[100:103], v[176:179], v[28:43]
  ds_read_b128 v[96:99], v1 offset:52224
  buffer_load_dwordx4 v[220:223], v25, s[40:43], s75 offen offset:1024 sc1
  v_mfma_f32_32x32x16_bf16 v[44:59], v[104:107], v[176:179], v[44:59]
  ds_read_b128 v[100:103], v1 offset:27648
  s_waitcnt vmcnt(8)
  v_xor_b32 v184, v184, v14
  v_xor_b32 v185, v185, v15
  v_xor_b32 v188, v188, v14
  s_waitcnt lgkmcnt(2)
  v_mfma_f32_32x32x16_bf16 v[28:43], v[108:111], v[180:183], v[28:43]
  ds_read_b128 v[104:107], v1 offset:60416
  v_xor_b32 v189, v189, v15
  v_or3_b32 v13, v184, v185, v188
  v_bitop3_b32 v13, v13, v189, s25 bitop3:0xa8
  buffer_load_dwordx4 v[224:227], v25, s[40:43], s69 offen offset:2048 sc1
  v_mfma_f32_32x32x16_bf16 v[44:59], v[112:115], v[180:183], v[44:59]
  ds_read_b128 v[108:111], v26 offset:25600
  v_cmp_ne_u32 vcc, 0, v13
  v_mfma_f32_32x32x16_bf16 v[60:75], v[116:119], v[152:155], v[60:75]
  ds_read_b128 v[112:115], v1 offset:4096
  s_cbranch_vccnz xr_25
xd_26:
  v_mfma_f32_32x32x16_bf16 v[28:43], v[92:95], v[184:187], v[28:43]
  ds_read_b128 v[116:119], v1 offset:36864
  buffer_load_dwordx4 v[228:231], v25, s[40:43], s71 offen offset:2048 sc1
  s_waitcnt lgkmcnt(2)
  v_mfma_f32_32x32x16_bf16 v[44:59], v[96:99], v[184:187], v[44:59]
  ds_read_b128 v[92:95], v1 offset:12288
  s_waitcnt vmcnt(8)
  v_xor_b32 v192, v192, v14
  v_xor_b32 v193, v193, v15
  v_xor_b32 v196, v196, v14
  v_mfma_f32_32x32x16_bf16 v[28:43], v[100:103], v[188:191], v[28:43]
  ds_read_b128 v[96:99], v1 offset:45056
  v_xor_b32 v197, v197, v15
  v_or3_b32 v13, v192, v193, v196
  v_bitop3_b32 v13, v13, v197, s25 bitop3:0xa8
  buffer_load_dwordx4 v[232:235], v25, s[40:43], s73 offen offset:2048 sc1
  v_mfma_f32_32x32x16_bf16 v[44:59], v[104:107], v[188:191], v[44:59]
  ds_read_b128 v[100:103], v26 offset:2048
  v_cmp_ne_u32 vcc, 0, v13
  v_mfma_f32_32x32x16_bf16 v[60:75], v[108:111], v[156:159], v[60:75]
  ds_read_b128 v[104:107], v1 offset:20480
  s_cbranch_vccnz xr_28
xd_29:
  s_waitcnt lgkmcnt(2)
  v_mfma_f32_32x32x16_bf16 v[28:43], v[112:115], v[192:195], v[28:43]
  ds_read_b128 v[108:111], v1 offset:53248
  buffer_load_dwordx4 v[236:239], v25, s[40:43], s75 offen offset:2048 sc1
  v_mfma_f32_32x32x16_bf16 v[44:59], v[116:119], v[192:195], v[44:59]
  ds_read_b128 v[112:115], v1 offset:28672
  s_waitcnt vmcnt(8)
  v_xor_b32 v200, v200, v14
  v_xor_b32 v201, v201, v15
  v_xor_b32 v204, v204, v14
  v_mfma_f32_32x32x16_bf16 v[28:43], v[92:95], v[196:199], v[28:43]
  ds_read_b128 v[116:119], v1 offset:61440
  v_xor_b32 v205, v205, v15
  v_or3_b32 v13, v200, v201, v204
  v_bitop3_b32 v13, v13, v205, s25 bitop3:0xa8
  buffer_load_dwordx4 v[240:243], v25, s[40:43], s69 offen offset:3072 sc1
  v_mfma_f32_32x32x16_bf16 v[44:59], v[96:99], v[196:199], v[44:59]
  ds_read_b128 v[92:95], v26 offset:10240
  v_cmp_ne_u32 vcc, 0, v13
  s_waitcnt lgkmcnt(2)
  v_mfma_f32_32x32x16_bf16 v[60:75], v[100:103], v[160:163], v[60:75]
  ds_read_b128 v[96:99], v1 offset:5120
  s_cbranch_vccnz xr_31
xd_32:
  v_mfma_f32_32x32x16_bf16 v[28:43], v[104:107], v[200:203], v[28:43]
  ds_read_b128 v[100:103], v1 offset:37888
  buffer_load_dwordx4 v[244:247], v25, s[40:43], s71 offen offset:3072 sc1
  v_mfma_f32_32x32x16_bf16 v[44:59], v[108:111], v[200:203], v[44:59]
  ds_read_b128 v[104:107], v1 offset:13312
  s_waitcnt vmcnt(8)
  v_xor_b32 v208, v208, v14
  v_xor_b32 v209, v209, v15
  v_xor_b32 v212, v212, v14
  v_mfma_f32_32x32x16_bf16 v[28:43], v[112:115], v[204:207], v[28:43]
  ds_read_b128 v[108:111], v1 offset:46080
  v_xor_b32 v213, v213, v15
  v_or3_b32 v13, v208, v209, v212
  v_bitop3_b32 v13, v13, v213, s25 bitop3:0xa8
  buffer_load_dwordx4 v[248:251], v25, s[40:43], s73 offen offset:3072 sc1
  s_waitcnt lgkmcnt(2)
  v_mfma_f32_32x32x16_bf16 v[44:59], v[116:119], v[204:207], v[44:59]
  ds_read_b128 v[112:115], v26 offset:18432
  v_cmp_ne_u32 vcc, 0, v13
  v_mfma_f32_32x32x16_bf16 v[60:75], v[92:95], v[164:167], v[60:75]
  ds_read_b128 v[116:119], v1 offset:21504
  s_cbranch_vccnz xr_34
xd_35:
  v_mfma_f32_32x32x16_bf16 v[28:43], v[96:99], v[208:211], v[28:43]
  ds_read_b128 v[92:95], v1 offset:54272
  buffer_load_dwordx4 v[252:255], v25, s[40:43], s75 offen offset:3072 sc1
  v_mfma_f32_32x32x16_bf16 v[44:59], v[100:103], v[208:211], v[44:59]
  ds_read_b128 v[96:99], v1 offset:29696
  s_waitcnt vmcnt(8)
  v_xor_b32 v216, v216, v14
  v_xor_b32 v217, v217, v15
  v_xor_b32 v220, v220, v14
  s_waitcnt lgkmcnt(14)
  s_add_u32 m0, s36, 98304
  s_add_u32 s6, s5, 98304
  buffer_load_dwordx4 v1, s[40:43], s6 offen offset:0 sc1 lds
  s_waitcnt lgkmcnt(2)
  v_mfma_f32_32x32x16_bf16 v[28:43], v[104:107], v[212:215], v[28:43]
  ds_read_b128 v[100:103], v1 offset:62464
  v_xor_b32 v221, v221, v15
  v_or3_b32 v13, v216, v217, v220
  v_bitop3_b32 v13, v13, v221, s25 bitop3:0xa8
  v_mfma_f32_32x32x16_bf16 v[44:59], v[108:111], v[212:215], v[44:59]
  ds_read_b128 v[104:107], v26 offset:26624
  v_cmp_ne_u32 vcc, 0, v13
  buffer_load_dwordx4 v1, s[40:43], s6 offen offset:1024 sc1 lds
  v_mfma_f32_32x32x16_bf16 v[60:75], v[112:115], v[168:171], v[60:75]
  ds_read_b128 v[108:111], v1 offset:6144
  s_cbranch_vccnz xr_37
xd_38:
  v_mfma_f32_32x32x16_bf16 v[28:43], v[116:119], v[216:219], v[28:43]
  ds_read_b128 v[112:115], v1 offset:38912
  buffer_load_dwordx4 v1, s[40:43], s6 offen offset:2048 sc1 lds
  s_waitcnt lgkmcnt(2)
  v_mfma_f32_32x32x16_bf16 v[44:59], v[92:95], v[216:219], v[44:59]
  ds_read_b128 v[116:119], v1 offset:14336
  s_waitcnt vmcnt(9)
  v_xor_b32 v224, v224, v14
  v_xor_b32 v225, v225, v15
  v_xor_b32 v228, v228, v14
  v_mfma_f32_32x32x16_bf16 v[28:43], v[96:99], v[220:223], v[28:43]
  ds_read_b128 v[92:95], v1 offset:47104
  v_xor_b32 v229, v229, v15
  v_or3_b32 v13, v224, v225, v228
  v_bitop3_b32 v13, v13, v229, s25 bitop3:0xa8
  buffer_load_dwordx4 v1, s[40:43], s6 offen offset:3072 sc1 lds
  v_mfma_f32_32x32x16_bf16 v[44:59], v[100:103], v[220:223], v[44:59]
  ds_read_b128 v[96:99], v26 offset:3072
  v_cmp_ne_u32 vcc, 0, v13
  v_mfma_f32_32x32x16_bf16 v[60:75], v[104:107], v[172:175], v[60:75]
  ds_read_b128 v[100:103], v1 offset:22528
  s_add_u32 m0, s36, 102400
  s_add_u32 s6, s5, 102400
  buffer_load_dwordx4 v1, s[40:43], s6 offen offset:0 sc1 lds
  s_cbranch_vccnz xr_40
xd_41:
  s_waitcnt lgkmcnt(2)
  v_mfma_f32_32x32x16_bf16 v[28:43], v[108:111], v[224:227], v[28:43]
  ds_read_b128 v[104:107], v1 offset:55296
  v_mfma_f32_32x32x16_bf16 v[44:59], v[112:115], v[224:227], v[44:59]
  ds_read_b128 v[108:111], v1 offset:30720
  s_waitcnt vmcnt(9)
  v_xor_b32 v232, v232, v14
  v_xor_b32 v233, v233, v15
  v_xor_b32 v236, v236, v14
  buffer_load_dwordx4 v1, s[40:43], s6 offen offset:1024 sc1 lds
  v_mfma_f32_32x32x16_bf16 v[28:43], v[116:119], v[228:231], v[28:43]
  ds_read_b128 v[112:115], v1 offset:63488
  v_xor_b32 v237, v237, v15
  v_or3_b32 v13, v232, v233, v236
  v_bitop3_b32 v13, v13, v237, s25 bitop3:0xa8
  v_mfma_f32_32x32x16_bf16 v[44:59], v[92:95], v[228:231], v[44:59]
  ds_read_b128 v[116:119], v26 offset:11264
  v_cmp_ne_u32 vcc, 0, v13
  s_waitcnt lgkmcnt(2)
  v_mfma_f32_32x32x16_bf16 v[60:75], v[96:99], v[176:179], v[60:75]
  ds_read_b128 v[92:95], v1 offset:7168
  buffer_load_dwordx4 v1, s[40:43], s6 offen offset:2048 sc1 lds
  s_cbranch_vccnz xr_43
xd_44:
  v_mfma_f32_32x32x16_bf16 v[28:43], v[100:103], v[232:235], v[28:43]
  ds_read_b128 v[96:99], v1 offset:39936
  v_mfma_f32_32x32x16_bf16 v[44:59], v[104:107], v[232:235], v[44:59]
  ds_read_b128 v[100:103], v1 offset:15360
  s_waitcnt vmcnt(9)
  v_xor_b32 v240, v240, v14
  v_xor_b32 v241, v241, v15
  v_xor_b32 v244, v244, v14
  buffer_load_dwordx4 v1, s[40:43], s6 offen offset:3072 sc1 lds
  v_mfma_f32_32x32x16_bf16 v[28:43], v[108:111], v[236:239], v[28:43]
  ds_read_b128 v[104:107], v1 offset:48128
  v_xor_b32 v245, v245, v15
  v_or3_b32 v13, v240, v241, v244
  v_bitop3_b32 v13, v13, v245, s25 bitop3:0xa8
  s_waitcnt lgkmcnt(2)
  v_mfma_f32_32x32x16_bf16 v[44:59], v[112:115], v[236:239], v[44:59]
  ds_read_b128 v[108:111], v26 offset:19456
  v_cmp_ne_u32 vcc, 0, v13
  s_add_u32 m0, s36, 131072
  s_add_u32 s6, s5, 131072
  buffer_load_dwordx4 v1, s[40:43], s6 offen offset:0 sc1 lds
  v_mfma_f32_32x32x16_bf16 v[60:75], v[116:119], v[180:183], v[60:75]
  ds_read_b128 v[112:115], v1 offset:23552
  s_cbranch_vccnz xr_46
xd_47:
  v_mfma_f32_32x32x16_bf16 v[28:43], v[92:95], v[240:243], v[28:43]
  ds_read_b128 v[116:119], v1 offset:56320
  buffer_load_dwordx4 v1, s[40:43], s6 offen offset:1024 sc1 lds
  v_mfma_f32_32x32x16_bf16 v[44:59], v[96:99], v[240:243], v[44:59]
  ds_read_b128 v[92:95], v1 offset:31744
  s_waitcnt vmcnt(10)
  v_xor_b32 v248, v248, v14
  v_xor_b32 v249, v249, v15
  v_xor_b32 v252, v252, v14
  s_waitcnt lgkmcnt(2)
  v_mfma_f32_32x32x16_bf16 v[28:43], v[100:103], v[244:247], v[28:43]
  ds_read_b128 v[96:99], v1 offset:64512
  v_xor_b32 v253, v253, v15
  v_or3_b32 v13, v248, v249, v252
  v_bitop3_b32 v13, v13, v253, s25 bitop3:0xa8
  buffer_load_dwordx4 v1, s[40:43], s6 offen offset:2048 sc1 lds
  v_mfma_f32_32x32x16_bf16 v[44:59], v[104:107], v[244:247], v[44:59]
  ds_read_b128 v[100:103], v26 offset:27648
  v_cmp_ne_u32 vcc, 0, v13
  v_mfma_f32_32x32x16_bf16 v[60:75], v[108:111], v[184:187], v[60:75]
  ds_read_b128 v[104:107], v26 offset:4096
  s_cbranch_vccnz xr_49
xd_50:
  v_mfma_f32_32x32x16_bf16 v[28:43], v[112:115], v[248:251], v[28:43]
  ds_read_b128 v[108:111], v26 offset:12288
  buffer_load_dwordx4 v1, s[40:43], s6 offen offset:3072 sc1 lds
  s_waitcnt lgkmcnt(2)
  v_mfma_f32_32x32x16_bf16 v[44:59], v[116:119], v[248:251], v[44:59]
  ds_read_b128 v[112:115], v26 offset:20480
  v_mfma_f32_32x32x16_bf16 v[28:43], v[92:95], v[252:255], v[28:43]
  ds_read_b128 v[116:119], v26 offset:28672
  s_add_u32 m0, s36, 135168
  s_add_u32 s6, s5, 135168
  buffer_load_dwordx4 v1, s[40:43], s6 offen offset:0 sc1 lds
  v_mfma_f32_32x32x16_bf16 v[44:59], v[96:99], v[252:255], v[44:59]
  ds_read_b128 v[92:95], v26 offset:5120
  v_mfma_f32_32x32x16_bf16 v[60:75], v[100:103], v[188:191], v[60:75]
  ds_read_b128 v[96:99], v26 offset:13312
  buffer_load_dwordx4 v1, s[40:43], s6 offen offset:1024 sc1 lds
  s_waitcnt lgkmcnt(2)
  v_mfma_f32_32x32x16_bf16 v[60:75], v[104:107], v[192:195], v[60:75]
  ds_read_b128 v[100:103], v26 offset:21504
  v_mfma_f32_32x32x16_bf16 v[60:75], v[108:111], v[196:199], v[60:75]
  ds_read_b128 v[104:107], v26 offset:29696
  buffer_load_dwordx4 v1, s[40:43], s6 offen offset:2048 sc1 lds
  v_fma_f32 v120, -v28, v28, s30
  v_fma_f32 v121, -v29, v29, s30
  v_fma_f32 v122, -v30, v30, s30
  v_mfma_f32_32x32x16_bf16 v[60:75], v[112:115], v[200:203], v[60:75]
  ds_read_b128 v[108:111], v26 offset:6144
  v_fma_f32 v123, -v31, v31, s30
  v_mul_f32 v120, v120, v28
  v_mul_f32 v121, v121, v29
  v_mfma_f32_32x32x16_bf16 v[60:75], v[116:119], v[204:207], v[60:75]
  ds_read_b128 v[112:115], v26 offset:14336
  buffer_load_dwordx4 v1, s[40:43], s6 offen offset:3072 sc1 lds
  v_mul_f32 v122, v122, v30
  v_mul_f32 v123, v123, v31
  v_exp_f32 v120, v120
  v_mul_f32 v36, v36, v28
  s_waitcnt lgkmcnt(2)
  v_mfma_f32_32x32x16_bf16 v[60:75], v[92:95], v[208:211], v[60:75]
  ds_read_b128 v[116:119], v26 offset:22528
  v_exp_f32 v121, v121
  v_mul_f32 v37, v37, v29
  v_exp_f32 v122, v122
  v_mfma_f32_32x32x16_bf16 v[60:75], v[96:99], v[212:215], v[60:75]
  ds_read_b128 v[92:95], v26 offset:30720
  v_mul_f32 v38, v38, v30
  v_exp_f32 v123, v123
  v_mul_f32 v39, v39, v31
  v_mfma_f32_32x32x16_bf16 v[60:75], v[100:103], v[216:219], v[60:75]
  ds_read_b128 v[96:99], v26 offset:7168
  v_fma_f32 v120, v120, s31, s31
  v_fma_f32 v121, v121, s31, s31
  v_fma_f32 v122, v122, s31, s31
  v_fma_f32 v123, v123, s31, s31
  v_mfma_f32_32x32x16_bf16 v[60:75], v[104:107], v[220:223], v[60:75]
  ds_read_b128 v[100:103], v26 offset:15360
  v_rcp_f32 v120, v120
  v_rcp_f32 v121, v121
  v_rcp_f32 v122, v122
  s_waitcnt lgkmcnt(2)
  v_mfma_f32_32x32x16_bf16 v[60:75], v[108:111], v[224:227], v[60:75]
  ds_read_b128 v[104:107], v26 offset:23552
  v_rcp_f32 v123, v123
  v_mul_f32 v36, v36, v120
  v_mul_f32 v37, v37, v121
  v_mfma_f32_32x32x16_bf16 v[60:75], v[112:115], v[228:231], v[60:75]
  ds_read_b128 v[108:111], v26 offset:31744
  v_mul_f32 v38, v38, v122
  v_mul_f32 v39, v39, v123
  v_cvt_pk_bf16_f32 v16, v36, v37
  v_cvt_pk_bf16_f32 v17, v38, v39
  s_waitcnt vmcnt(8)
  s_barrier
  v_mfma_f32_32x32x16_bf16 v[60:75], v[116:119], v[232:235], v[60:75]
  ds_read_b128 v[112:115], v26 offset:32768
  s_add_u32 m0, s36, 0
  s_add_u32 s6, s5, 163840
  buffer_load_dwordx4 v1, s[40:43], s6 offen offset:0 sc1 lds
  v_bfi_b32 v16, s25, v20, v16
  v_bfi_b32 v17, s25, v23, v17
  v_fma_f32 v120, -v32, v32, s30
  v_mfma_f32_32x32x16_bf16 v[60:75], v[92:95], v[236:239], v[60:75]
  ds_read_b128 v[116:119], v26 offset:40960
  v_fma_f32 v121, -v33, v33, s30
  v_fma_f32 v122, -v34, v34, s30
  v_fma_f32 v123, -v35, v35, s30
  s_waitcnt lgkmcnt(2)
  v_mfma_f32_32x32x16_bf16 v[60:75], v[96:99], v[240:243], v[60:75]
  ds_read_b128 v[92:95], v26 offset:49152
  buffer_load_dwordx4 v1, s[40:43], s6 offen offset:1024 sc1 lds
  v_mul_f32 v120, v120, v32
  v_mul_f32 v121, v121, v33
  v_mul_f32 v122, v122, v34
  v_mfma_f32_32x32x16_bf16 v[60:75], v[100:103], v[244:247], v[60:75]
  ds_read_b128 v[96:99], v26 offset:57344
  v_mul_f32 v123, v123, v35
  v_exp_f32 v120, v120
  v_mul_f32 v40, v40, v32
  v_exp_f32 v121, v121
  v_mfma_f32_32x32x16_bf16 v[60:75], v[104:107], v[248:251], v[60:75]
  ds_read_b128 v[100:103], v26 offset:33792
  buffer_load_dwordx4 v1, s[40:43], s6 offen offset:2048 sc1 lds
  v_mul_f32 v41, v41, v33
  v_exp_f32 v122, v122
  v_mul_f32 v42, v42, v34
  v_mfma_f32_32x32x16_bf16 v[60:75], v[108:111], v[252:255], v[60:75]
  ds_read_b128 v[104:107], v26 offset:41984
  v_exp_f32 v123, v123
  v_mul_f32 v43, v43, v35
  v_fma_f32 v120, v120, s31, s31
  s_waitcnt lgkmcnt(2)
  v_mfma_f32_32x32x16_bf16 v[76:91], v[112:115], v[128:131], 0
  ds_read_b128 v[108:111], v26 offset:50176
  buffer_load_dwordx4 v1, s[40:43], s6 offen offset:3072 sc1 lds
  v_fma_f32 v121, v121, s31, s31
  v_fma_f32 v122, v122, s31, s31
  v_fma_f32 v123, v123, s31, s31
  v_rcp_f32 v120, v120
  v_mfma_f32_32x32x16_bf16 v[76:91], v[116:119], v[132:135], v[76:91]
  ds_read_b128 v[112:115], v26 offset:58368
  v_rcp_f32 v121, v121
  v_rcp_f32 v122, v122
  v_rcp_f32 v123, v123
  v_mfma_f32_32x32x16_bf16 v[76:91], v[92:95], v[136:139], v[76:91]
  ds_read_b128 v[116:119], v26 offset:34816
  s_add_u32 m0, s36, 4096
  s_add_u32 s6, s5, 167936
  buffer_load_dwordx4 v1, s[40:43], s6 offen offset:0 sc1 lds
  v_mul_f32 v40, v40, v120
  v_mul_f32 v41, v41, v121
  v_mul_f32 v42, v42, v122
  v_mfma_f32_32x32x16_bf16 v[76:91], v[96:99], v[140:143], v[76:91]
  ds_read_b128 v[92:95], v26 offset:43008
  v_mul_f32 v43, v43, v123
  v_cvt_pk_bf16_f32 v18, v40, v41
  v_cvt_pk_bf16_f32 v19, v42, v43
  buffer_store_dwordx4 v[16:19], v1, s[40:43], s12 offen offset:0 sc1
  s_waitcnt lgkmcnt(2)
  v_mfma_f32_32x32x16_bf16 v[76:91], v[100:103], v[144:147], v[76:91]
  ds_read_b128 v[96:99], v26 offset:51200
  buffer_load_dwordx4 v1, s[40:43], s6 offen offset:1024 sc1 lds
  v_fma_f32 v120, -v44, v44, s30
  v_fma_f32 v121, -v45, v45, s30
  v_fma_f32 v122, -v46, v46, s30
  v_mfma_f32_32x32x16_bf16 v[76:91], v[104:107], v[148:151], v[76:91]
  ds_read_b128 v[100:103], v26 offset:59392
  v_fma_f32 v123, -v47, v47, s30
  v_mul_f32 v120, v120, v44
  v_mul_f32 v121, v121, v45
  v_mfma_f32_32x32x16_bf16 v[76:91], v[108:111], v[152:155], v[76:91]
  ds_read_b128 v[104:107], v26 offset:35840
  v_mul_f32 v122, v122, v46
  v_mul_f32 v123, v123, v47
  v_exp_f32 v120, v120
  v_mfma_f32_32x32x16_bf16 v[76:91], v[112:115], v[156:159], v[76:91]
  ds_read_b128 v[108:111], v26 offset:44032
  buffer_load_dwordx4 v1, s[40:43], s6 offen offset:2048 sc1 lds
  v_mul_f32 v52, v52, v44
  v_exp_f32 v121, v121
  v_mul_f32 v53, v53, v45
  v_exp_f32 v122, v122
  s_waitcnt lgkmcnt(2)
  v_mfma_f32_32x32x16_bf16 v[76:91], v[116:119], v[160:163], v[76:91]
  ds_read_b128 v[112:115], v26 offset:52224
  v_mul_f32 v54, v54, v46
  v_exp_f32 v123, v123
  v_mul_f32 v55, v55, v47
  v_mfma_f32_32x32x16_bf16 v[76:91], v[92:95], v[164:167], v[76:91]
  ds_read_b128 v[116:119], v26 offset:60416
  buffer_load_dwordx4 v1, s[40:43], s6 offen offset:3072 sc1 lds
  v_fma_f32 v120, v120, s31, s31
  v_fma_f32 v121, v121, s31, s31
  v_fma_f32 v122, v122, s31, s31
  v_mfma_f32_32x32x16_bf16 v[76:91], v[96:99], v[168:171], v[76:91]
  ds_read_b128 v[92:95], v26 offset:36864
  v_fma_f32 v123, v123, s31, s31
  v_rcp_f32 v120, v120
  v_rcp_f32 v121, v121
  v_rcp_f32 v122, v122
  v_mfma_f32_32x32x16_bf16 v[76:91], v[100:103], v[172:175], v[76:91]
  ds_read_b128 v[96:99], v26 offset:45056
  s_add_u32 m0, s36, 32768
  s_add_u32 s6, s5, 196608
  buffer_load_dwordx4 v1, s[40:43], s6 offen offset:0 sc1 lds
  v_rcp_f32 v123, v123
  v_mul_f32 v52, v52, v120
  v_mul_f32 v53, v53, v121
  s_waitcnt lgkmcnt(2)
  v_mfma_f32_32x32x16_bf16 v[76:91], v[104:107], v[176:179], v[76:91]
  ds_read_b128 v[100:103], v26 offset:53248
  v_mul_f32 v54, v54, v122
  v_mul_f32 v55, v55, v123
  v_cvt_pk_bf16_f32 v16, v52, v53
  v_mfma_f32_32x32x16_bf16 v[76:91], v[108:111], v[180:183], v[76:91]
  ds_read_b128 v[104:107], v26 offset:61440
  buffer_load_dwordx4 v1, s[40:43], s6 offen offset:1024 sc1 lds
  v_cvt_pk_bf16_f32 v17, v54, v55
  v_bfi_b32 v16, s25, v20, v16
  v_bfi_b32 v17, s25, v23, v17
  v_fma_f32 v120, -v48, v48, s30
  v_mfma_f32_32x32x16_bf16 v[76:91], v[112:115], v[184:187], v[76:91]
  ds_read_b128 v[108:111], v26 offset:37888
  v_fma_f32 v121, -v49, v49, s30
  v_fma_f32 v122, -v50, v50, s30
  v_fma_f32 v123, -v51, v51, s30
  v_mfma_f32_32x32x16_bf16 v[76:91], v[116:119], v[188:191], v[76:91]
  ds_read_b128 v[112:115], v26 offset:46080
  buffer_load_dwordx4 v1, s[40:43], s6 offen offset:2048 sc1 lds
  v_mul_f32 v120, v120, v48
  v_mul_f32 v121, v121, v49
  v_mul_f32 v122, v122, v50
  s_waitcnt lgkmcnt(2)
  v_mfma_f32_32x32x16_bf16 v[76:91], v[92:95], v[192:195], v[76:91]
  ds_read_b128 v[116:119], v26 offset:54272
  v_mul_f32 v123, v123, v51
  v_exp_f32 v120, v120
  v_mul_f32 v56, v56, v48
  v_mfma_f32_32x32x16_bf16 v[76:91], v[96:99], v[196:199], v[76:91]
  ds_read_b128 v[92:95], v26 offset:62464
  v_exp_f32 v121, v121
  v_mul_f32 v57, v57, v49
  v_exp_f32 v122, v122
  v_mul_f32 v58, v58, v50
  v_mfma_f32_32x32x16_bf16 v[76:91], v[100:103], v[200:203], v[76:91]
  ds_read_b128 v[96:99], v26 offset:38912
  buffer_load_dwordx4 v1, s[40:43], s6 offen offset:3072 sc1 lds
  v_exp_f32 v123, v123
  v_mul_f32 v59, v59, v51
  v_fma_f32 v120, v120, s31, s31
  v_mfma_f32_32x32x16_bf16 v[76:91], v[104:107], v[204:207], v[76:91]
  ds_read_b128 v[100:103], v26 offset:47104
  v_fma_f32 v121, v121, s31, s31
  v_fma_f32 v122, v122, s31, s31
  v_fma_f32 v123, v123, s31, s31
  s_waitcnt lgkmcnt(2)
  v_mfma_f32_32x32x16_bf16 v[76:91], v[108:111], v[208:211], v[76:91]
  ds_read_b128 v[104:107], v26 offset:55296
  s_add_u32 m0, s36, 36864
  s_add_u32 s6, s5, 200704
  buffer_load_dwordx4 v1, s[40:43], s6 offen offset:0 sc1 lds
  v_rcp_f32 v120, v120
  v_rcp_f32 v121, v121
  v_rcp_f32 v122, v122
  v_rcp_f32 v123, v123
  v_mfma_f32_32x32x16_bf16 v[76:91], v[112:115], v[212:215], v[76:91]
  ds_read_b128 v[108:111], v26 offset:63488
  v_mul_f32 v56, v56, v120
  v_mul_f32 v57, v57, v121
  v_mul_f32 v58, v58, v122
  v_mfma_f32_32x32x16_bf16 v[76:91], v[116:119], v[216:219], v[76:91]
  ds_read_b128 v[112:115], v26 offset:39936
  buffer_load_dwordx4 v1, s[40:43], s6 offen offset:1024 sc1 lds
  v_mul_f32 v59, v59, v123
  v_cvt_pk_bf16_f32 v18, v56, v57
  v_cvt_pk_bf16_f32 v19, v58, v59
  v_mfma_f32_32x32x16_bf16 v[76:91], v[92:95], v[220:223], v[76:91]
  ds_read_b128 v[116:119], v26 offset:48128
  buffer_store_dwordx4 v[16:19], v1, s[40:43], s12 offen offset:1024 sc1
  buffer_store_dwordx4 v[4:7], v3, s[40:43], s63 offen offset:0 sc1
  v_fma_f32 v120, -v60, v60, s30
  v_fma_f32 v121, -v61, v61, s30
  v_fma_f32 v122, -v62, v62, s30
  s_waitcnt lgkmcnt(2)
  v_mfma_f32_32x32x16_bf16 v[76:91], v[96:99], v[224:227], v[76:91]
  ds_read_b128 v[92:95], v26 offset:56320
  buffer_load_dwordx4 v1, s[40:43], s6 offen offset:2048 sc1 lds
  v_fma_f32 v123, -v63, v63, s30
  v_mul_f32 v120, v120, v60
  v_mul_f32 v121, v121, v61
  v_mfma_f32_32x32x16_bf16 v[76:91], v[100:103], v[228:231], v[76:91]
  ds_read_b128 v[96:99], v26 offset:64512
  v_mul_f32 v122, v122, v62
  v_mul_f32 v123, v123, v63
  v_exp_f32 v120, v120
  s_waitcnt vmcnt(18)
  s_barrier
  v_mfma_f32_32x32x16_bf16 v[76:91], v[104:107], v[232:235], v[76:91]
  ds_read_b128 v[100:103], v27 offset:0
  s_add_u32 m0, s36, 65536
  v_add_u32 v124, 32768, v124
  global_load_lds_dwordx4 v124, s[28:29] offset:0
  v_mul_f32 v68, v68, v60
  v_exp_f32 v121, v121
  v_mul_f32 v69, v69, v61
  v_mfma_f32_32x32x16_bf16 v[76:91], v[108:111], v[236:239], v[76:91]
  ds_read_b128 v[104:107], v27 offset:8192
  v_exp_f32 v122, v122
  v_mul_f32 v70, v70, v62
  v_exp_f32 v123, v123
  v_mul_f32 v71, v71, v63
  s_waitcnt lgkmcnt(2)
  v_mfma_f32_32x32x16_bf16 v[76:91], v[112:115], v[240:243], v[76:91]
  ds_read_b128 v[108:111], v27 offset:16384
  v_fma_f32 v120, v120, s31, s31
  v_fma_f32 v121, v121, s31, s31
  v_fma_f32 v122, v122, s31, s31
  v_mfma_f32_32x32x16_bf16 v[76:91], v[116:119], v[244:247], v[76:91]
  ds_read_b128 v[112:115], v27 offset:24576
  global_load_lds_dwordx4 v124, s[28:29] offset:1024
  v_fma_f32 v123, v123, s31, s31
  v_rcp_f32 v120, v120
  v_rcp_f32 v121, v121
  v_mfma_f32_32x32x16_bf16 v[76:91], v[92:95], v[248:251], v[76:91]
  ds_read_b128 v[116:119], v27 offset:1024
  v_rcp_f32 v122, v122
  v_rcp_f32 v123, v123
  v_mul_f32 v68, v68, v120
  v_mul_f32 v69, v69, v121
  v_mfma_f32_32x32x16_bf16 v[76:91], v[96:99], v[252:255], v[76:91]
  ds_read_b128 v[92:95], v27 offset:9216
  global_load_lds_dwordx4 v124, s[28:29] offset:2048
  v_mul_f32 v70, v70, v122
  v_mul_f32 v71, v71, v123
  v_cvt_pk_bf16_f32 v16, v68, v69
  s_waitcnt lgkmcnt(2)
  v_mfma_f32_32x32x16_bf16 v[28:43], v[100:103], v[128:131], 0
  ds_read_b128 v[96:99], v27 offset:17408
  v_cvt_pk_bf16_f32 v17, v70, v71
  v_bfi_b32 v16, s25, v20, v16
  v_bfi_b32 v17, s25, v23, v17
  v_mfma_f32_32x32x16_bf16 v[28:43], v[104:107], v[132:135], v[28:43]
  ds_read_b128 v[100:103], v27 offset:25600
  global_load_lds_dwordx4 v124, s[28:29] offset:3072
  v_fma_f32 v120, -v64, v64, s30
  v_fma_f32 v121, -v65, v65, s30
  v_fma_f32 v122, -v66, v66, s30
  v_fma_f32 v123, -v67, v67, s30
  v_mfma_f32_32x32x16_bf16 v[28:43], v[108:111], v[136:139], v[28:43]
  ds_read_b128 v[104:107], v27 offset:2048
  v_mul_f32 v120, v120, v64
  v_mul_f32 v121, v121, v65
  v_mul_f32 v122, v122, v66
  v_mfma_f32_32x32x16_bf16 v[28:43], v[112:115], v[140:143], v[28:43]
  ds_read_b128 v[108:111], v27 offset:10240
  s_add_u32 m0, s36, 69632
  v_add_u32 v124, 32768, v124
  global_load_lds_dwordx4 v124, s[28:29] offset:0
  v_mul_f32 v123, v123, v67
  v_exp_f32 v120, v120
  v_mul_f32 v72, v72, v64
  s_waitcnt lgkmcnt(2)
  v_mfma_f32_32x32x16_bf16 v[28:43], v[116:119], v[144:147], v[28:43]
  ds_read_b128 v[112:115], v27 offset:18432
  v_exp_f32 v121, v121
  v_mul_f32 v73, v73, v65
  v_exp_f32 v122, v122
  v_mfma_f32_32x32x16_bf16 v[28:43], v[92:95], v[148:151], v[28:43]
  ds_read_b128 v[116:119], v27 offset:26624
  global_load_lds_dwordx4 v124, s[28:29] offset:1024
  v_mul_f32 v74, v74, v66
  v_exp_f32 v123, v123
  v_mul_f32 v75, v75, v67
  v_fma_f32 v120, v120, s31, s31
  v_mfma_f32_32x32x16_bf16 v[28:43], v[96:99], v[152:155], v[28:43]
  ds_read_b128 v[92:95], v27 offset:3072
  v_fma_f32 v121, v121, s31, s31
  v_fma_f32 v122, v122, s31, s31
  v_fma_f32 v123, v123, s31, s31
  v_mfma_f32_32x32x16_bf16 v[28:43], v[100:103], v[156:159], v[28:43]
  ds_read_b128 v[96:99], v27 offset:11264
  v_rcp_f32 v120, v120
  v_rcp_f32 v121, v121
  v_rcp_f32 v122, v122
  s_waitcnt lgkmcnt(2)
  v_mfma_f32_32x32x16_bf16 v[28:43], v[104:107], v[160:163], v[28:43]
  ds_read_b128 v[100:103], v27 offset:19456
  global_load_lds_dwordx4 v124, s[28:29] offset:2048
  v_rcp_f32 v123, v123
  v_mul_f32 v72, v72, v120
  v_mul_f32 v73, v73, v121
  v_mul_f32 v74, v74, v122
  v_mfma_f32_32x32x16_bf16 v[28:43], v[108:111], v[164:167], v[28:43]
  ds_read_b128 v[104:107], v27 offset:27648
  v_mul_f32 v75, v75, v123
  v_cvt_pk_bf16_f32 v18, v72, v73
  v_cvt_pk_bf16_f32 v19, v74, v75
  v_mfma_f32_32x32x16_bf16 v[28:43], v[112:115], v[168:171], v[28:43]
  ds_read_b128 v[108:111], v27 offset:4096
  global_load_lds_dwordx4 v124, s[28:29] offset:3072
  buffer_store_dwordx4 v[16:19], v1, s[40:43], s12 offen offset:2048 sc1
  buffer_store_dwordx4 v[8:11], v3, s[40:43], s63 offen offset:1024 sc1
  v_fma_f32 v120, -v76, v76, s30
  v_fma_f32 v121, -v77, v77, s30
  v_mfma_f32_32x32x16_bf16 v[28:43], v[116:119], v[172:175], v[28:43]
  ds_read_b128 v[112:115], v27 offset:12288
  v_fma_f32 v122, -v78, v78, s30
  v_fma_f32 v123, -v79, v79, s30
  v_mul_f32 v120, v120, v76
  v_mul_f32 v121, v121, v77
  s_waitcnt lgkmcnt(2)
  v_mfma_f32_32x32x16_bf16 v[28:43], v[92:95], v[176:179], v[28:43]
  ds_read_b128 v[116:119], v27 offset:20480
  s_add_u32 m0, s36, 36864
  s_nop 0
  buffer_load_dwordx4 v1, s[40:43], s6 offen offset:3072 sc1 lds
  v_mul_f32 v122, v122, v78
  v_mul_f32 v123, v123, v79
  v_exp_f32 v120, v120
  v_mfma_f32_32x32x16_bf16 v[28:43], v[96:99], v[180:183], v[28:43]
  ds_read_b128 v[92:95], v27 offset:28672
  v_mul_f32 v84, v84, v76
  v_exp_f32 v121, v121
  v_mul_f32 v85, v85, v77
  v_mfma_f32_32x32x16_bf16 v[28:43], v[100:103], v[184:187], v[28:43]
  ds_read_b128 v[96:99], v27 offset:5120
  v_exp_f32 v122, v122
  v_mul_f32 v86, v86, v78
  v_exp_f32 v123, v123
  v_mfma_f32_32x32x16_bf16 v[28:43], v[104:107], v[188:191], v[28:43]
  ds_read_b128 v[100:103], v27 offset:13312
  v_mul_f32 v87, v87, v79
  v_fma_f32 v120, v120, s31, s31
  v_fma_f32 v121, v121, s31, s31
  v_fma_f32 v122, v122, s31, s31
  s_waitcnt lgkmcnt(2)
  v_mfma_f32_32x32x16_bf16 v[28:43], v[108:111], v[192:195], v[28:43]
  ds_read_b128 v[104:107], v27 offset:21504
  v_fma_f32 v123, v123, s31, s31
  v_rcp_f32 v120, v120
  v_rcp_f32 v121, v121
  v_mfma_f32_32x32x16_bf16 v[28:43], v[112:115], v[196:199], v[28:43]
  ds_read_b128 v[108:111], v27 offset:29696
  v_rcp_f32 v122, v122
  v_rcp_f32 v123, v123
  v_mul_f32 v84, v84, v120
  v_mfma_f32_32x32x16_bf16 v[28:43], v[116:119], v[200:203], v[28:43]
  ds_read_b128 v[112:115], v27 offset:6144
  v_mul_f32 v85, v85, v121
  v_mul_f32 v86, v86, v122
  v_mul_f32 v87, v87, v123
  v_cvt_pk_bf16_f32 v16, v84, v85
  v_mfma_f32_32x32x16_bf16 v[28:43], v[92:95], v[204:207], v[28:43]
  ds_read_b128 v[116:119], v27 offset:14336
  v_cvt_pk_bf16_f32 v17, v86, v87
  v_bfi_b32 v16, s25, v20, v16
  v_bfi_b32 v17, s25, v23, v17
  s_waitcnt lgkmcnt(2)
  v_mfma_f32_32x32x16_bf16 v[28:43], v[96:99], v[208:211], v[28:43]
  ds_read_b128 v[92:95], v27 offset:22528
  v_fma_f32 v120, -v80, v80, s30
  v_fma_f32 v121, -v81, v81, s30
  v_fma_f32 v122, -v82, v82, s30
  v_mfma_f32_32x32x16_bf16 v[28:43], v[100:103], v[212:215], v[28:43]
  ds_read_b128 v[96:99], v27 offset:30720
  v_fma_f32 v123, -v83, v83, s30
  v_mul_f32 v120, v120, v80
  v_mul_f32 v121, v121, v81
  v_mul_f32 v122, v122, v82
  v_mfma_f32_32x32x16_bf16 v[28:43], v[104:107], v[216:219], v[28:43]
  ds_read_b128 v[100:103], v27 offset:7168
  v_mul_f32 v123, v123, v83
  v_exp_f32 v120, v120
  v_mul_f32 v88, v88, v80
  v_mfma_f32_32x32x16_bf16 v[28:43], v[108:111], v[220:223], v[28:43]
  ds_read_b128 v[104:107], v27 offset:15360
  v_exp_f32 v121, v121
  v_mul_f32 v89, v89, v81
  v_exp_f32 v122, v122
  s_waitcnt lgkmcnt(2)
  v_mfma_f32_32x32x16_bf16 v[28:43], v[112:115], v[224:227], v[28:43]
  ds_read_b128 v[108:111], v27 offset:23552
  v_mul_f32 v90, v90, v82
  v_exp_f32 v123, v123
  v_mul_f32 v91, v91, v83
  v_mfma_f32_32x32x16_bf16 v[28:43], v[116:119], v[228:231], v[28:43]
  ds_read_b128 v[112:115], v27 offset:31744
  v_fma_f32 v120, v120, s31, s31
  v_fma_f32 v121, v121, s31, s31
  v_fma_f32 v122, v122, s31, s31
  v_fma_f32 v123, v123, s31, s31
  s_waitcnt vmcnt(20)
  s_barrier
  v_mfma_f32_32x32x16_bf16 v[28:43], v[92:95], v[232:235], v[28:43]
  ds_read_b128 v[116:119], v1 offset:0
  s_add_u32 m0, s36, 98304
  v_add_u32 v124, 32768, v124
  global_load_lds_dwordx4 v124, s[28:29] offset:0
  v_rcp_f32 v120, v120
  v_rcp_f32 v121, v121
  v_rcp_f32 v122, v122
  v_mfma_f32_32x32x16_bf16 v[28:43], v[96:99], v[236:239], v[28:43]
  ds_read_b128 v[92:95], v1 offset:8192
  v_rcp_f32 v123, v123
  v_mul_f32 v88, v88, v120
  v_mul_f32 v89, v89, v121
  s_waitcnt lgkmcnt(2)
  v_mfma_f32_32x32x16_bf16 v[28:43], v[100:103], v[240:243], v[28:43]
  ds_read_b128 v[96:99], v1 offset:16384
  global_load_lds_dwordx4 v124, s[28:29] offset:1024
  v_mul_f32 v90, v90, v122
  v_mul_f32 v91, v91, v123
  v_cvt_pk_bf16_f32 v18, v88, v89
  v_cvt_pk_bf16_f32 v19, v90, v91
  v_mfma_f32_32x32x16_bf16 v[28:43], v[104:107], v[244:247], v[28:43]
  ds_read_b128 v[100:103], v1 offset:24576
  buffer_store_dwordx4 v[16:19], v1, s[40:43], s12 offen offset:3072 sc1
  v_mfma_f32_32x32x16_bf16 v[28:43], v[108:111], v[248:251], v[28:43]
  ds_read_b128 v[104:107], v1 offset:1024
  global_load_lds_dwordx4 v124, s[28:29] offset:2048
  v_mfma_f32_32x32x16_bf16 v[28:43], v[112:115], v[252:255], v[28:43]
  ds_read_b128 v[108:111], v1 offset:9216
  s_waitcnt lgkmcnt(2)
  v_mfma_f32_32x32x16_bf16 v[44:59], v[116:119], v[128:131], 0
  ds_read_b128 v[112:115], v1 offset:17408
  global_load_lds_dwordx4 v124, s[28:29] offset:3072
  v_mfma_f32_32x32x16_bf16 v[44:59], v[92:95], v[132:135], v[44:59]
  ds_read_b128 v[116:119], v1 offset:25600
  v_mfma_f32_32x32x16_bf16 v[44:59], v[96:99], v[136:139], v[44:59]
  ds_read_b128 v[92:95], v1 offset:2048
  s_add_u32 m0, s36, 102400
  v_add_u32 v124, 32768, v124
  global_load_lds_dwordx4 v124, s[28:29] offset:0
  s_waitcnt vmcnt(9)
  ds_read_b64_tr_b16 a[128:129], v125 offset:0
  ds_read_b64_tr_b16 a[130:131], v125 offset:4096
  v_mfma_f32_32x32x16_bf16 v[44:59], v[100:103], v[140:143], v[44:59]
  ds_read_b128 v[96:99], v1 offset:10240
  v_fma_f32 v120, -v28, v28, s30
  v_fma_f32 v121, -v29, v29, s30
  v_fma_f32 v122, -v30, v30, s30
  v_fma_f32 v123, -v31, v31, s30
  ds_read_b64_tr_b16 a[132:133], v125 offset:512
  s_waitcnt lgkmcnt(5)
  v_mfma_f32_32x32x16_bf16 v[44:59], v[104:107], v[144:147], v[44:59]
  ds_read_b128 v[100:103], v1 offset:18432
  global_load_lds_dwordx4 v124, s[28:29] offset:1024
  v_mul_f32 v120, v120, v28
  v_mul_f32 v121, v121, v29
  v_mul_f32 v122, v122, v30
  ds_read_b64_tr_b16 a[134:135], v125 offset:4608
  v_mfma_f32_32x32x16_bf16 v[44:59], v[108:111], v[148:151], v[44:59]
  ds_read_b128 v[104:107], v1 offset:26624
  v_mul_f32 v123, v123, v31
  v_exp_f32 v120, v120
  v_mul_f32 v36, v36, v28
  ds_read_b64_tr_b16 a[136:137], v125 offset:1024
  v_mfma_f32_32x32x16_bf16 v[44:59], v[112:115], v[152:155], v[44:59]
  ds_read_b128 v[108:111], v1 offset:3072
  v_exp_f32 v121, v121
  v_mul_f32 v37, v37, v29
  v_exp_f32 v122, v122
  v_mul_f32 v38, v38, v30
  ds_read_b64_tr_b16 a[138:139], v125 offset:5120
  v_mfma_f32_32x32x16_bf16 v[44:59], v[116:119], v[156:159], v[44:59]
  ds_read_b128 v[112:115], v1 offset:11264
  global_load_lds_dwordx4 v124, s[28:29] offset:2048
  v_exp_f32 v123, v123
  v_mul_f32 v39, v39, v31
  v_fma_f32 v120, v120, s31, s31
  ds_read_b64_tr_b16 a[140:141], v125 offset:1536
  s_waitcnt lgkmcnt(5)
  v_mfma_f32_32x32x16_bf16 v[44:59], v[92:95], v[160:163], v[44:59]
  ds_read_b128 v[116:119], v1 offset:19456
  v_fma_f32 v121, v121, s31, s31
  v_fma_f32 v122, v122, s31, s31
  v_fma_f32 v123, v123, s31, s31
  ds_read_b64_tr_b16 a[142:143], v125 offset:5632
  v_mfma_f32_32x32x16_bf16 v[44:59], v[96:99], v[164:167], v[44:59]
  ds_read_b128 v[92:95], v1 offset:27648
  global_load_lds_dwordx4 v124, s[28:29] offset:3072
  v_rcp_f32 v120, v120
  v_rcp_f32 v121, v121
  v_rcp_f32 v122, v122
  v_rcp_f32 v123, v123
  ds_read_b64_tr_b16 a[144:145], v125 offset:2048
  v_mfma_f32_32x32x16_bf16 v[44:59], v[100:103], v[168:171], v[44:59]
  ds_read_b128 v[96:99], v1 offset:4096
  v_mul_f32 v36, v36, v120
  v_mul_f32 v37, v37, v121
  v_mul_f32 v38, v38, v122
  ds_read_b64_tr_b16 a[146:147], v125 offset:6144
  v_mfma_f32_32x32x16_bf16 v[44:59], v[104:107], v[172:175], v[44:59]
  ds_read_b128 v[100:103], v1 offset:12288
  v_mul_f32 v39, v39, v123
  v_cvt_pk_bf16_f32 v16, v36, v37
  v_cvt_pk_bf16_f32 v17, v38, v39
  ds_read_b64_tr_b16 a[148:149], v125 offset:2560
  s_waitcnt lgkmcnt(5)
  v_mfma_f32_32x32x16_bf16 v[44:59], v[108:111], v[176:179], v[44:59]
  ds_read_b128 v[104:107], v1 offset:20480
  v_bfi_b32 v16, s25, v20, v16
  v_bfi_b32 v17, s25, v23, v17
  v_fma_f32 v120, -v32, v32, s30
  ds_read_b64_tr_b16 a[150:151], v125 offset:6656
  v_mfma_f32_32x32x16_bf16 v[44:59], v[112:115], v[180:183], v[44:59]
  ds_read_b128 v[108:111], v1 offset:28672
  v_fma_f32 v121, -v33, v33, s30
  v_fma_f32 v122, -v34, v34, s30
  v_fma_f32 v123, -v35, v35, s30
  v_mul_f32 v120, v120, v32
  ds_read_b64_tr_b16 a[152:153], v125 offset:3072
  v_mfma_f32_32x32x16_bf16 v[44:59], v[116:119], v[184:187], v[44:59]
  ds_read_b128 v[112:115], v1 offset:5120
  v_mul_f32 v121, v121, v33
  v_mul_f32 v122, v122, v34
  v_mul_f32 v123, v123, v35
  ds_read_b64_tr_b16 a[154:155], v125 offset:7168
  v_mfma_f32_32x32x16_bf16 v[44:59], v[92:95], v[188:191], v[44:59]
  ds_read_b128 v[116:119], v1 offset:13312
  v_exp_f32 v120, v120
  v_mul_f32 v40, v40, v32
  v_exp_f32 v121, v121
  ds_read_b64_tr_b16 a[156:157], v125 offset:3584
  s_waitcnt lgkmcnt(5)
  v_mfma_f32_32x32x16_bf16 v[44:59], v[96:99], v[192:195], v[44:59]
  ds_read_b128 v[92:95], v1 offset:21504
  v_mul_f32 v41, v41, v33
  v_exp_f32 v122, v122
  v_mul_f32 v42, v42, v34
  v_exp_f32 v123, v123
  ds_read_b64_tr_b16 a[158:159], v125 offset:7680
  v_mfma_f32_32x32x16_bf16 v[44:59], v[100:103], v[196:199], v[44:59]
  ds_read_b128 v[96:99], v1 offset:29696
  s_waitcnt lgkmcnt(1)
  s_add_u32 m0, s36, 65536
  v_add_u32 v124, 32768, v124
  global_load_lds_dwordx4 v124, s[28:29] offset:0
  v_mul_f32 v43, v43, v35
  v_fma_f32 v120, v120, s31, s31
  v_fma_f32 v121, v121, s31, s31
  v_mfma_f32_32x32x16_bf16 v[44:59], v[104:107], v[200:203], v[44:59]
  ds_read_b128 v[100:103], v1 offset:6144
  v_fma_f32 v122, v122, s31, s31
  v_fma_f32 v123, v123, s31, s31
  v_rcp_f32 v120, v120
  v_mfma_f32_32x32x16_bf16 v[44:59], v[108:111], v[204:207], v[44:59]
  ds_read_b128 v[104:107], v1 offset:14336
  global_load_lds_dwordx4 v124, s[28:29] offset:1024
  v_rcp_f32 v121, v121
  v_rcp_f32 v122, v122
  v_rcp_f32 v123, v123
  v_mul_f32 v40, v40, v120
  s_waitcnt lgkmcnt(2)
  v_mfma_f32_32x32x16_bf16 v[44:59], v[112:115], v[208:211], v[44:59]
  ds_read_b128 v[108:111], v1 offset:22528
  v_mul_f32 v41, v41, v121
  v_mul_f32 v42, v42, v122
  v_mul_f32 v43, v43, v123
  v_mfma_f32_32x32x16_bf16 v[44:59], v[116:119], v[212:215], v[44:59]
  ds_read_b128 v[112:115], v1 offset:30720
  global_load_lds_dwordx4 v124, s[28:29] offset:2048
  v_cvt_pk_bf16_f32 v18, v40, v41
  v_cvt_pk_bf16_f32 v19, v42, v43
  buffer_store_dwordx4 v[16:19], v1, s[40:43], s13 offen offset:0 sc1
  s_waitcnt vmcnt(14)
  s_mov_b32 exec_hi, 0
  buffer_store_dword v2, v127, s[40:43], s14 offen sc1
  s_mov_b32 exec_hi, -1
  v_mfma_f32_32x32x16_bf16 v[44:59], v[92:95], v[216:219], v[44:59]
  ds_read_b128 v[116:119], v1 offset:7168
  v_mfma_f32_32x32x16_bf16 v[44:59], v[96:99], v[220:223], v[44:59]
  ds_read_b128 v[92:95], v1 offset:15360
  global_load_lds_dwordx4 v124, s[28:29] offset:3072
  s_waitcnt lgkmcnt(2)
  v_mfma_f32_32x32x16_bf16 v[44:59], v[100:103], v[224:227], v[44:59]
  ds_read_b128 v[96:99], v1 offset:23552
  v_mfma_f32_32x32x16_bf16 v[44:59], v[104:107], v[228:231], v[44:59]
  ds_read_b128 v[100:103], v1 offset:31744
  s_add_u32 m0, s36, 69632
  v_add_u32 v124, 32768, v124
  global_load_lds_dwordx4 v124, s[28:29] offset:0
  s_waitcnt vmcnt(16)
  s_barrier
  v_mfma_f32_32x32x16_bf16 v[44:59], v[108:111], v[232:235], v[44:59]
  ds_read_b128 v[104:107], v1 offset:32768
  v_mfma_f32_32x32x16_bf16 v[44:59], v[112:115], v[236:239], v[44:59]
  ds_read_b128 v[108:111], v1 offset:40960
  global_load_lds_dwordx4 v124, s[28:29] offset:1024
  s_waitcnt lgkmcnt(2)
  v_mfma_f32_32x32x16_bf16 v[44:59], v[116:119], v[240:243], v[44:59]
  ds_read_b128 v[112:115], v1 offset:49152
  v_mfma_f32_32x32x16_bf16 v[44:59], v[92:95], v[244:247], v[44:59]
  ds_read_b128 v[116:119], v1 offset:57344
  v_mfma_f32_32x32x16_bf16 v[44:59], v[96:99], v[248:251], v[44:59]
  ds_read_b128 v[92:95], v1 offset:33792
  global_load_lds_dwordx4 v124, s[28:29] offset:2048
  s_waitcnt vmcnt(9)
  ds_read_b64_tr_b16 a[160:161], v125 offset:32768
  ds_read_b64_tr_b16 a[162:163], v125 offset:36864
  v_mfma_f32_32x32x16_bf16 v[44:59], v[100:103], v[252:255], v[44:59]
  ds_read_b128 v[96:99], v1 offset:41984
  ds_read_b64_tr_b16 a[164:165], v125 offset:33280
  ds_read_b64_tr_b16 a[166:167], v125 offset:37376
  s_waitcnt lgkmcnt(6)
  v_mfma_f32_32x32x16_bf16 v[60:75], v[104:107], v[128:131], 0
  ds_read_b128 v[100:103], v1 offset:50176
  global_load_lds_dwordx4 v124, s[28:29] offset:3072
  ds_read_b64_tr_b16 a[168:169], v125 offset:33792
  ds_read_b64_tr_b16 a[170:171], v125 offset:37888
  v_mfma_f32_32x32x16_bf16 v[60:75], v[108:111], v[132:135], v[60:75]
  ds_read_b128 v[104:107], v1 offset:58368
  ds_read_b64_tr_b16 a[172:173], v125 offset:34304
  ds_read_b64_tr_b16 a[174:175], v125 offset:38400
  v_mfma_f32_32x32x16_bf16 v[60:75], v[112:115], v[136:139], v[60:75]
  ds_read_b128 v[108:111], v1 offset:34816
  buffer_load_dwordx4 v[128:131], v1, s[40:43], s76 offen offset:0 sc1
  ds_read_b64_tr_b16 a[176:177], v125 offset:34816
  ds_read_b64_tr_b16 a[178:179], v125 offset:38912
  v_mfma_f32_32x32x16_bf16 v[60:75], v[116:119], v[140:143], v[60:75]
  ds_read_b128 v[112:115], v1 offset:43008
  v_fma_f32 v120, -v44, v44, s30
  v_fma_f32 v121, -v45, v45, s30
  v_fma_f32 v122, -v46, v46, s30
  ds_read_b64_tr_b16 a[180:181], v125 offset:35328
  s_waitcnt lgkmcnt(7)
  v_mfma_f32_32x32x16_bf16 v[60:75], v[92:95], v[144:147], v[60:75]
  ds_read_b128 v[116:119], v1 offset:51200
  buffer_load_dwordx4 v[132:135], v21, s[40:43], s76 offen offset:0 sc1
  v_fma_f32 v123, -v47, v47, s30
  v_mul_f32 v120, v120, v44
  v_mul_f32 v121, v121, v45
  v_mul_f32 v122, v122, v46
  ds_read_b64_tr_b16 a[182:183], v125 offset:39424
  v_mfma_f32_32x32x16_bf16 v[60:75], v[96:99], v[148:151], v[60:75]
  ds_read_b128 v[92:95], v1 offset:59392
  v_mul_f32 v123, v123, v47
  v_exp_f32 v120, v120
  v_mul_f32 v52, v52, v44
  ds_read_b64_tr_b16 a[184:185], v125 offset:35840
  v_mfma_f32_32x32x16_bf16 v[60:75], v[100:103], v[152:155], v[60:75]
  ds_read_b128 v[96:99], v1 offset:35840
  buffer_load_dwordx4 v[136:139], v1, s[40:43], s78 offen offset:0 sc1
  v_exp_f32 v121, v121
  v_mul_f32 v53, v53, v45
  v_exp_f32 v122, v122
  ds_read_b64_tr_b16 a[186:187], v125 offset:39936
  v_mfma_f32_32x32x16_bf16 v[60:75], v[104:107], v[156:159], v[60:75]
  ds_read_b128 v[100:103], v1 offset:44032
  v_mul_f32 v54, v54, v46
  v_exp_f32 v123, v123
  v_mul_f32 v55, v55, v47
  v_fma_f32 v120, v120, s31, s31
  ds_read_b64_tr_b16 a[188:189], v125 offset:36352
  s_waitcnt lgkmcnt(5)
  v_mfma_f32_32x32x16_bf16 v[60:75], v[108:111], v[160:163], v[60:75]
  ds_read_b128 v[104:107], v1 offset:52224
  v_fma_f32 v121, v121, s31, s31
  v_fma_f32 v122, v122, s31, s31
  v_fma_f32 v123, v123, s31, s31
  ds_read_b64_tr_b16 a[190:191], v125 offset:40448
  v_mfma_f32_32x32x16_bf16 v[60:75], v[112:115], v[164:167], v[60:75]
  ds_read_b128 v[108:111], v1 offset:60416
  buffer_load_dwordx4 v[140:143], v21, s[40:43], s78 offen offset:0 sc1
  v_rcp_f32 v120, v120
  v_rcp_f32 v121, v121
  v_rcp_f32 v122, v122
  v_mfma_f32_32x32x16_bf16 v[60:75], v[116:119], v[168:171], v[60:75]
  ds_read_b128 v[112:115], v1 offset:36864
  v_rcp_f32 v123, v123
  v_mul_f32 v52, v52, v120
  v_mul_f32 v53, v53, v121
  v_mfma_f32_32x32x16_bf16 v[60:75], v[92:95], v[172:175], v[60:75]
  ds_read_b128 v[116:119], v1 offset:45056
  buffer_load_dwordx4 v[144:147], v1, s[40:43], s80 offen offset:0 sc1
  v_mul_f32 v54, v54, v122
  v_mul_f32 v55, v55, v123
  v_cvt_pk_bf16_f32 v16, v52, v53
  v_cvt_pk_bf16_f32 v17, v54, v55
  s_waitcnt lgkmcnt(2)
  v_mfma_f32_32x32x16_bf16 v[60:75], v[96:99], v[176:179], v[60:75]
  ds_read_b128 v[92:95], v1 offset:53248
  v_bfi_b32 v16, s25, v20, v16
  v_bfi_b32 v17, s25, v23, v17
  v_fma_f32 v120, -v48, v48, s30
  v_mfma_f32_32x32x16_bf16 v[60:75], v[100:103], v[180:183], v[60:75]
  ds_read_b128 v[96:99], v1 offset:61440
  buffer_load_dwordx4 v[148:151], v21, s[40:43], s80 offen offset:0 sc1
  v_fma_f32 v121, -v49, v49, s30
  v_fma_f32 v122, -v50, v50, s30
  v_fma_f32 v123, -v51, v51, s30
  v_mfma_f32_32x32x16_bf16 v[60:75], v[104:107], v[184:187], v[60:75]
  ds_read_b128 v[100:103], v1 offset:37888
  v_mul_f32 v120, v120, v48
  v_mul_f32 v121, v121, v49
  v_mul_f32 v122, v122, v50
  v_mul_f32 v123, v123, v51
  v_mfma_f32_32x32x16_bf16 v[60:75], v[108:111], v[188:191], v[60:75]
  ds_read_b128 v[104:107], v1 offset:46080
  buffer_load_dwordx4 v[152:155], v1, s[40:43], s32 offen offset:0 sc1
  v_exp_f32 v120, v120
  v_mul_f32 v56, v56, v48
  v_exp_f32 v121, v121
  s_waitcnt lgkmcnt(2)
  v_mfma_f32_32x32x16_bf16 v[60:75], v[112:115], v[192:195], v[60:75]
  ds_read_b128 v[108:111], v1 offset:54272
  v_mul_f32 v57, v57, v49
  v_exp_f32 v122, v122
  v_mul_f32 v58, v58, v50
  v_mfma_f32_32x32x16_bf16 v[60:75], v[116:119], v[196:199], v[60:75]
  ds_read_b128 v[112:115], v1 offset:62464
  buffer_load_dwordx4 v[156:159], v21, s[40:43], s32 offen offset:0 sc1
  v_exp_f32 v123, v123
  v_mul_f32 v59, v59, v51
  v_fma_f32 v120, v120, s31, s31
  v_fma_f32 v121, v121, s31, s31
  v_mfma_f32_32x32x16_bf16 v[60:75], v[92:95], v[200:203], v[60:75]
  ds_read_b128 v[116:119], v1 offset:38912
  v_fma_f32 v122, v122, s31, s31
  v_fma_f32 v123, v123, s31, s31
  v_rcp_f32 v120, v120
  v_mfma_f32_32x32x16_bf16 v[60:75], v[96:99], v[204:207], v[60:75]
  ds_read_b128 v[92:95], v1 offset:47104
  v_rcp_f32 v121, v121
  v_rcp_f32 v122, v122
  v_rcp_f32 v123, v123
  s_waitcnt lgkmcnt(2)
  v_mfma_f32_32x32x16_bf16 v[60:75], v[100:103], v[208:211], v[60:75]
  ds_read_b128 v[96:99], v1 offset:55296
  buffer_load_dwordx4 v[160:163], v1, s[40:43], s76 offen offset:1024 sc1
  v_mul_f32 v56, v56, v120
  v_mul_f32 v57, v57, v121
  v_mul_f32 v58, v58, v122
  s_waitcnt vmcnt(9)
  ds_read_b64_tr_b16 a[192:193], v125 offset:0
  v_mfma_f32_32x32x16_bf16 v[60:75], v[104:107], v[212:215], v[60:75]
  ds_read_b128 v[100:103], v1 offset:63488
  v_mul_f32 v59, v59, v123
  v_cvt_pk_bf16_f32 v18, v56, v57
  v_cvt_pk_bf16_f32 v19, v58, v59
  buffer_store_dwordx4 v[16:19], v1, s[40:43], s13 offen offset:1024 sc1
  ds_read_b64_tr_b16 a[194:195], v125 offset:4096
  v_mfma_f32_32x32x16_bf16 v[60:75], v[108:111], v[216:219], v[60:75]
  ds_read_b128 v[104:107], v1 offset:39936
  buffer_load_dwordx4 v[164:167], v21, s[40:43], s76 offen offset:1024 sc1
  ds_read_b64_tr_b16 a[196:197], v125 offset:512
  ds_read_b64_tr_b16 a[198:199], v125 offset:4608
  v_mfma_f32_32x32x16_bf16 v[60:75], v[112:115], v[220:223], v[60:75]
  ds_read_b128 v[108:111], v1 offset:48128
  ds_read_b64_tr_b16 a[200:201], v125 offset:1024
  ds_read_b64_tr_b16 a[202:203], v125 offset:5120
  s_waitcnt lgkmcnt(7)
  v_mfma_f32_32x32x16_bf16 v[60:75], v[116:119], v[224:227], v[60:75]
  ds_read_b128 v[112:115], v1 offset:56320
  buffer_load_dwordx4 v[168:171], v1, s[40:43], s78 offen offset:1024 sc1
  ds_read_b64_tr_b16 a[204:205], v125 offset:1536
  ds_read_b64_tr_b16 a[206:207], v125 offset:5632
  v_mfma_f32_32x32x16_bf16 v[60:75], v[92:95], v[228:231], v[60:75]
  ds_read_b128 v[116:119], v1 offset:64512
  ds_read_b64_tr_b16 a[208:209], v125 offset:2048
  ds_read_b64_tr_b16 a[210:211], v125 offset:6144
  v_mfma_f32_32x32x16_bf16 v[60:75], v[96:99], v[232:235], v[60:75]
  buffer_load_dwordx4 v[172:175], v21, s[40:43], s78 offen offset:1024 sc1
  ds_read_b64_tr_b16 a[212:213], v125 offset:2560
  ds_read_b64_tr_b16 a[214:215], v125 offset:6656
  v_mfma_f32_32x32x16_bf16 v[60:75], v[100:103], v[236:239], v[60:75]
  ds_read_b64_tr_b16 a[216:217], v125 offset:3072
  ds_read_b64_tr_b16 a[218:219], v125 offset:7168
  s_waitcnt vmcnt(11)
  v_xor_b32 v128, v128, v20
  v_xor_b32 v129, v129, v23
  v_xor_b32 v132, v132, v20
  s_waitcnt lgkmcnt(6)
  v_mfma_f32_32x32x16_bf16 v[60:75], v[104:107], v[240:243], v[60:75]
  buffer_load_dwordx4 v[176:179], v1, s[40:43], s80 offen offset:1024 sc1
  ds_read_b64_tr_b16 a[220:221], v125 offset:3584
  ds_read_b64_tr_b16 a[222:223], v125 offset:7680
  v_xor_b32 v133, v133, v23
  v_or3_b32 v25, v128, v129, v132
  v_bitop3_b32 v25, v25, v133, s25 bitop3:0xa8
  v_mfma_f32_32x32x16_bf16 v[60:75], v[108:111], v[244:247], v[60:75]
  v_cmp_ne_u32 vcc, 0, v25
  v_mfma_f32_32x32x16_bf16 v[60:75], v[112:115], v[248:251], v[60:75]
  v_mfma_f32_32x32x16_bf16 v[60:75], v[116:119], v[252:255], v[60:75]
  buffer_load_dwordx4 v[180:183], v21, s[40:43], s80 offen offset:1024 sc1
  v_lshlrev_b32 v92, 2, v0
  v_add_u32 v92, 139264, v92
  ds_write_b32 v92, v12
  s_cbranch_vccnz ar_51
ad_52:
  s_waitcnt  lgkmcnt(14)
  v_mfma_f32_32x32x16_bf16 a[224:239], a[0:3], v[128:131], 0
  buffer_load_dwordx4 v[184:187], v1, s[40:43], s32 offen offset:1024 sc1
  s_waitcnt vmcnt(12)
  v_xor_b32 v136, v136, v20
  v_xor_b32 v137, v137, v23
  v_xor_b32 v140, v140, v20
  v_bfe_u32 v92, v0, 5, 1
  v_and_b32 v93, 0x1f0, v1
  v_mfma_f32_32x32x16_bf16 a[240:255], a[4:7], v[128:131], 0
  v_xor_b32_e64 v141, v141, v23
  v_or3_b32 v25, v136, v137, v140
  v_bitop3_b32 v25, v25, v141, s25 bitop3:0xa8
  v_fma_f32 v120, -v60, v60, s30
  v_fma_f32 v121, -v61, v61, s30
  v_fma_f32 v122, -v62, v62, s30
  v_fma_f32 v123, -v63, v63, s30
  v_mul_f32 v120, v120, v60
  v_mfma_f32_32x32x16_bf16 v[28:43], a[0:3], v[132:135], 0
  buffer_load_dwordx4 v[188:191], v21, s[40:43], s32 offen offset:1024 sc1
  v_cmp_ne_u32 vcc, 0, v25
  v_mul_f32 v121, v121, v61
  v_mul_f32 v122, v122, v62
  v_mul_f32 v123, v123, v63
  v_exp_f32 v120, v120
  v_mul_f32 v68, v68, v60
  v_mfma_f32_32x32x16_bf16 v[76:91], a[4:7], v[132:135], 0
  buffer_load_dwordx4 v[192:195], v1, s[40:43], s76 offen offset:2048 sc1
  s_cbranch_vccnz ar_53
ad_54:
  v_exp_f32 v121, v121
  v_mul_f32 v69, v69, v61
  v_exp_f32 v122, v122
  v_mul_f32 v70, v70, v62
  v_exp_f32 v123, v123
  s_waitcnt  lgkmcnt(14)
  v_mfma_f32_32x32x16_bf16 a[224:239], a[56:59], v[136:139], a[224:239]
  s_waitcnt vmcnt(12)
  v_xor_b32 v144, v144, v20
  v_xor_b32 v145, v145, v23
  v_xor_b32 v148, v148, v20
  v_mul_f32 v71, v71, v63
  v_fma_f32 v120, v120, s31, s31
  v_fma_f32 v121, v121, s31, s31
  v_fma_f32 v122, v122, s31, s31
  v_fma_f32 v123, v123, s31, s31
  v_mfma_f32_32x32x16_bf16 a[240:255], a[60:63], v[136:139], a[240:255]
  buffer_load_dwordx4 v[196:199], v21, s[40:43], s76 offen offset:2048 sc1
  v_xor_b32 v149, v149, v23
  v_or3_b32 v25, v144, v145, v148
  v_bitop3_b32 v25, v25, v149, s25 bitop3:0xa8
  v_rcp_f32 v120, v120
  v_rcp_f32 v121, v121
  v_rcp_f32 v122, v122
  v_rcp_f32 v123, v123
  v_mul_f32 v68, v68, v120
  v_mfma_f32_32x32x16_bf16 v[28:43], a[56:59], v[140:143], v[28:43]
  v_cmp_ne_u32 vcc, 0, v25
  v_mul_f32 v69, v69, v121
  v_mul_f32 v70, v70, v122
  v_mul_f32 v71, v71, v123
  v_cvt_pk_bf16_f32 v16, v68, v69
  v_cvt_pk_bf16_f32 v17, v70, v71
  v_mfma_f32_32x32x16_bf16 v[76:91], a[60:63], v[140:143], v[76:91]
  buffer_load_dwordx4 v[200:203], v1, s[40:43], s78 offen offset:2048 sc1
  s_cbranch_vccnz ar_55
ad_56:
  v_bfi_b32 v16, s25, v20, v16
  v_bfi_b32 v17, s25, v23, v17
  v_fma_f32 v120, -v64, v64, s30
  v_fma_f32 v121, -v65, v65, s30
  v_fma_f32 v122, -v66, v66, s30
  s_waitcnt  lgkmcnt(14)
  v_mfma_f32_32x32x16_bf16 a[224:239], a[112:115], v[144:147], a[224:239]
  s_waitcnt vmcnt(12)
  v_xor_b32 v152, v152, v20
  v_xor_b32 v153, v153, v23
  v_xor_b32 v156, v156, v20
  v_fma_f32 v123, -v67, v67, s30
  v_mul_f32 v120, v120, v64
  v_mul_f32 v121, v121, v65
  v_mul_f32 v122, v122, v66
  v_mul_f32 v123, v123, v67
  v_mfma_f32_32x32x16_bf16 a[240:255], a[116:119], v[144:147], a[240:255]
  buffer_load_dwordx4 v[204:207], v21, s[40:43], s78 offen offset:2048 sc1
  v_xor_b32 v157, v157, v23
  v_or3_b32 v25, v152, v153, v156
  v_bitop3_b32 v25, v25, v157, s25 bitop3:0xa8
  v_exp_f32 v120, v120
  v_mul_f32 v72, v72, v64
  v_exp_f32 v121, v121
  v_mul_f32 v73, v73, v65
  v_exp_f32 v122, v122
  v_mfma_f32_32x32x16_bf16 v[28:43], a[112:115], v[148:151], v[28:43]
  v_cmp_ne_u32 vcc, 0, v25
  v_mul_f32 v74, v74, v66
  v_exp_f32 v123, v123
  v_mul_f32 v75, v75, v67
  v_fma_f32 v120, v120, s31, s31
  v_fma_f32 v121, v121, s31, s31
  v_mfma_f32_32x32x16_bf16 v[76:91], a[116:119], v[148:151], v[76:91]
  buffer_load_dwordx4 v[208:211], v1, s[40:43], s80 offen offset:2048 sc1
  s_cbranch_vccnz ar_57
ad_58:
  v_fma_f32 v122, v122, s31, s31
  v_fma_f32 v123, v123, s31, s31
  v_rcp_f32 v120, v120
  v_rcp_f32 v121, v121
  v_rcp_f32 v122, v122
  s_waitcnt  lgkmcnt(14)
  v_mfma_f32_32x32x16_bf16 a[224:239], a[168:171], v[152:155], a[224:239]
  buffer_load_dwordx4 v[212:215], v21, s[40:43], s80 offen offset:2048 sc1
  s_waitcnt vmcnt(12)
  v_xor_b32 v160, v160, v20
  v_xor_b32 v161, v161, v23
  v_xor_b32 v164, v164, v20
  v_rcp_f32 v123, v123
  v_mul_f32 v72, v72, v120
  v_mul_f32 v73, v73, v121
  v_mul_f32 v74, v74, v122
  v_mul_f32 v75, v75, v123
  v_mfma_f32_32x32x16_bf16 a[240:255], a[172:175], v[152:155], a[240:255]
  v_xor_b32 v165, v165, v23
  v_or3_b32 v25, v160, v161, v164
  v_bitop3_b32 v25, v25, v165, s25 bitop3:0xa8
  v_cvt_pk_bf16_f32 v18, v72, v73
  v_cvt_pk_bf16_f32 v19, v74, v75
  buffer_store_dwordx4 v[16:19], v1, s[40:43], s13 offen offset:2048 sc1
  v_mfma_f32_32x32x16_bf16 v[28:43], a[168:171], v[156:159], v[28:43]
  buffer_load_dwordx4 v[216:219], v1, s[40:43], s32 offen offset:2048 sc1
  v_cmp_ne_u32 vcc, 0, v25
  s_mul_i32 s58, s45, 18432
  s_add_u32 s58, s58, 65536
  v_mfma_f32_32x32x16_bf16 v[76:91], a[172:175], v[156:159], v[76:91]
  s_cbranch_vccnz ar_59
ad_60:
  v_mul_u32_u24 v92, 4608, v92
  v_add3_u32 v12, v92, v93, s58
  v_mfma_f32_32x32x16_bf16 a[224:239], a[8:11], v[160:163], a[224:239]
  buffer_load_dwordx4 v[220:223], v21, s[40:43], s32 offen offset:2048 sc1
  s_waitcnt vmcnt(13)
  v_xor_b32 v168, v168, v20
  v_xor_b32 v169, v169, v23
  v_xor_b32 v172, v172, v20
  v_and_b32 v92, 7, v0
  v_lshrrev_b32 v93, 3, v0
  v_mfma_f32_32x32x16_bf16 a[240:255], a[12:15], v[160:163], a[240:255]
  v_xor_b32 v173, v173, v23
  v_or3_b32 v25, v168, v169, v172
  v_bitop3_b32 v25, v25, v173, s25 bitop3:0xa8
  v_mul_u32_u24 v94, 576, v92
  v_lshl_add_u32 v13, v93, 4, v94
  v_mfma_f32_32x32x16_bf16 v[28:43], a[8:11], v[164:167], v[28:43]
  buffer_load_dwordx4 v[224:227], v1, s[40:43], s76 offen offset:3072 sc1
  v_cmp_ne_u32 vcc, 0, v25
  v_add_u32 v13, 65536, v13
  s_lshl_b32 s58, s55, 7
  v_mfma_f32_32x32x16_bf16 v[76:91], a[12:15], v[164:167], v[76:91]
  s_cbranch_vccnz ar_61
ad_62:
  s_add_u32 s58, s58, 139264
  v_lshl_add_u32 v14, v92, 4, s58
  v_mfma_f32_32x32x16_bf16 a[224:239], a[64:67], v[168:171], a[224:239]
  buffer_load_dwordx4 v[228:231], v21, s[40:43], s76 offen offset:3072 sc1
  s_waitcnt vmcnt(13)
  v_xor_b32 v176, v176, v20
  v_xor_b32 v177, v177, v23
  v_xor_b32 v180, v180, v20
  s_add_u32 s60, s34, 32768
  s_addc_u32 s61, s35, 0
  v_add_u32 v15, 36864, v13
  v_mfma_f32_32x32x16_bf16 a[240:255], a[68:71], v[168:171], a[240:255]
  buffer_load_dwordx4 v[232:235], v1, s[40:43], s78 offen offset:3072 sc1
  v_xor_b32 v181, v181, v23
  v_or3_b32 v25, v176, v177, v180
  v_bitop3_b32 v25, v25, v181, s25 bitop3:0xa8
  v_mfma_f32_32x32x16_bf16 v[28:43], a[64:67], v[172:175], v[28:43]
  v_cmp_ne_u32 vcc, 0, v25
  v_mfma_f32_32x32x16_bf16 v[76:91], a[68:71], v[172:175], v[76:91]
  buffer_load_dwordx4 v[236:239], v21, s[40:43], s78 offen offset:3072 sc1
  s_cbranch_vccnz ar_63
ad_64:
  buffer_load_dword v3, v24, s[40:43], 0 offen sc1
  v_mfma_f32_32x32x16_bf16 a[224:239], a[120:123], v[176:179], a[224:239]
  s_waitcnt vmcnt(14)
  v_xor_b32 v184, v184, v20
  v_xor_b32 v185, v185, v23
  v_xor_b32 v188, v188, v20
  v_mfma_f32_32x32x16_bf16 a[240:255], a[124:127], v[176:179], a[240:255]
  buffer_load_dwordx4 v[240:243], v1, s[40:43], s80 offen offset:3072 sc1
  v_xor_b32 v189, v189, v23
  v_or3_b32 v25, v184, v185, v188
  v_bitop3_b32 v25, v25, v189, s25 bitop3:0xa8
  v_mfma_f32_32x32x16_bf16 v[28:43], a[120:123], v[180:183], v[28:43]
  v_cmp_ne_u32 vcc, 0, v25
  v_mfma_f32_32x32x16_bf16 v[76:91], a[124:127], v[180:183], v[76:91]
  buffer_load_dwordx4 v[244:247], v21, s[40:43], s80 offen offset:3072 sc1
  s_cbranch_vccnz ar_65
ad_66:
  s_waitcnt  lgkmcnt(14)
  v_mfma_f32_32x32x16_bf16 a[224:239], a[176:179], v[184:187], a[224:239]
  s_waitcnt vmcnt(14)
  v_xor_b32 v192, v192, v20
  v_xor_b32 v193, v193, v23
  v_xor_b32 v196, v196, v20
  v_mfma_f32_32x32x16_bf16 a[240:255], a[180:183], v[184:187], a[240:255]
  buffer_load_dwordx4 v[248:251], v1, s[40:43], s32 offen offset:3072 sc1
  v_xor_b32 v197, v197, v23
  v_or3_b32 v25, v192, v193, v196
  v_bitop3_b32 v25, v25, v197, s25 bitop3:0xa8
  v_mfma_f32_32x32x16_bf16 v[28:43], a[176:179], v[188:191], v[28:43]
  buffer_load_dwordx4 v[252:255], v21, s[40:43], s32 offen offset:3072 sc1
  v_cmp_ne_u32 vcc, 0, v25
  v_mfma_f32_32x32x16_bf16 v[76:91], a[180:183], v[188:191], v[76:91]
  s_cbranch_vccnz ar_67
ad_68:
  v_mfma_f32_32x32x16_bf16 a[224:239], a[16:19], v[192:195], a[224:239]
  buffer_load_dwordx4 v[128:131], v1, s[40:43], s77 offen offset:0 sc1
  s_waitcnt vmcnt(15)
  v_xor_b32 v200, v200, v20
  v_xor_b32 v201, v201, v23
  v_xor_b32 v204, v204, v20
  v_mfma_f32_32x32x16_bf16 a[240:255], a[20:23], v[192:195], a[240:255]
  v_xor_b32 v205, v205, v23
  v_or3_b32 v25, v200, v201, v204
  v_bitop3_b32 v25, v25, v205, s25 bitop3:0xa8
  v_mfma_f32_32x32x16_bf16 v[28:43], a[16:19], v[196:199], v[28:43]
  buffer_load_dwordx4 v[132:135], v21, s[40:43], s77 offen offset:0 sc1
  v_cmp_ne_u32 vcc, 0, v25
  v_mfma_f32_32x32x16_bf16 v[76:91], a[20:23], v[196:199], v[76:91]
  s_cbranch_vccnz ar_69
ad_70:
  v_mfma_f32_32x32x16_bf16 a[224:239], a[72:75], v[200:203], a[224:239]
  buffer_load_dwordx4 v[136:139], v1, s[40:43], s79 offen offset:0 sc1
  s_waitcnt vmcnt(15)
  v_xor_b32 v208, v208, v20
  v_xor_b32 v209, v209, v23
  v_xor_b32 v212, v212, v20
  v_mfma_f32_32x32x16_bf16 a[240:255], a[76:79], v[200:203], a[240:255]
  v_xor_b32 v213, v213, v23
  v_or3_b32 v25, v208, v209, v212
  v_bitop3_b32 v25, v25, v213, s25 bitop3:0xa8
  v_mfma_f32_32x32x16_bf16 v[28:43], a[72:75], v[204:207], v[28:43]
  buffer_load_dwordx4 v[140:143], v21, s[40:43], s79 offen offset:0 sc1
  v_cmp_ne_u32 vcc, 0, v25
  v_mfma_f32_32x32x16_bf16 v[76:91], a[76:79], v[204:207], v[76:91]
  buffer_load_dwordx4 v[144:147], v1, s[40:43], s81 offen offset:0 sc1
  s_cbranch_vccnz ar_71
ad_72:
  v_mfma_f32_32x32x16_bf16 a[224:239], a[128:131], v[208:211], a[224:239]
  s_waitcnt vmcnt(14)
  v_xor_b32 v216, v216, v20
  v_xor_b32 v217, v217, v23
  v_xor_b32 v220, v220, v20
  v_mfma_f32_32x32x16_bf16 a[240:255], a[132:135], v[208:211], a[240:255]
  buffer_load_dwordx4 v[148:151], v21, s[40:43], s81 offen offset:0 sc1
  v_xor_b32 v221, v221, v23
  v_or3_b32 v25, v216, v217, v220
  v_bitop3_b32 v25, v25, v221, s25 bitop3:0xa8
  v_mfma_f32_32x32x16_bf16 v[28:43], a[128:131], v[212:215], v[28:43]
  v_cmp_ne_u32 vcc, 0, v25
  v_mfma_f32_32x32x16_bf16 v[76:91], a[132:135], v[212:215], v[76:91]
  buffer_load_dwordx4 v[152:155], v1, s[40:43], s33 offen offset:0 sc1
  s_cbranch_vccnz ar_73
ad_74:
  s_waitcnt vmcnt(11)
chk_75:
  v_cmp_ne_u32 vcc, v3, v2
  s_cmp_lg_u64 vcc, 0
  s_cbranch_scc1 retry_76
  s_mov_b32 s0, 7995392
  buffer_load_dwordx4 v[4:7], v22, s[40:43], s0 offen sc1
  s_mov_b32 s0, 8028160
  buffer_load_dwordx4 v[8:11], v22, s[40:43], s0 offen sc1
  s_waitcnt  lgkmcnt(14)
  v_mfma_f32_32x32x16_bf16 a[224:239], a[184:187], v[216:219], a[224:239]
  s_waitcnt vmcnt(16)
  v_xor_b32 v224, v224, v20
  v_xor_b32 v225, v225, v23
  v_xor_b32 v228, v228, v20
  v_mfma_f32_32x32x16_bf16 a[240:255], a[188:191], v[216:219], a[240:255]
  buffer_load_dwordx4 v[156:159], v21, s[40:43], s33 offen offset:0 sc1
  v_xor_b32 v229, v229, v23
  v_or3_b32 v25, v224, v225, v228
  v_bitop3_b32 v25, v25, v229, s25 bitop3:0xa8
  v_mfma_f32_32x32x16_bf16 v[28:43], a[184:187], v[220:223], v[28:43]
  v_cmp_ne_u32 vcc, 0, v25
  v_mfma_f32_32x32x16_bf16 v[76:91], a[188:191], v[220:223], v[76:91]
  buffer_load_dwordx4 v[160:163], v1, s[40:43], s77 offen offset:1024 sc1
  s_cbranch_vccnz ar_77
ad_78:
  v_mfma_f32_32x32x16_bf16 a[224:239], a[24:27], v[224:227], a[224:239]
  buffer_load_dwordx4 v[164:167], v21, s[40:43], s77 offen offset:1024 sc1
  s_waitcnt vmcnt(17)
  v_xor_b32 v232, v232, v20
  v_xor_b32 v233, v233, v23
  v_xor_b32 v236, v236, v20
  v_mfma_f32_32x32x16_bf16 a[240:255], a[28:31], v[224:227], a[240:255]
  v_xor_b32 v237, v237, v23
  v_or3_b32 v25, v232, v233, v236
  v_bitop3_b32 v25, v25, v237, s25 bitop3:0xa8
  v_mfma_f32_32x32x16_bf16 v[28:43], a[24:27], v[228:231], v[28:43]
  buffer_load_dwordx4 v[168:171], v1, s[40:43], s79 offen offset:1024 sc1
  v_cmp_ne_u32 vcc, 0, v25
  v_mfma_f32_32x32x16_bf16 v[76:91], a[28:31], v[228:231], v[76:91]
  s_cbranch_vccnz ar_79
ad_80:
  v_mfma_f32_32x32x16_bf16 a[224:239], a[80:83], v[232:235], a[224:239]
  buffer_load_dwordx4 v[172:175], v21, s[40:43], s79 offen offset:1024 sc1
  s_waitcnt vmcnt(16)
  v_xor_b32 v240, v240, v20
  v_xor_b32 v241, v241, v23
  v_xor_b32 v244, v244, v20
  v_mfma_f32_32x32x16_bf16 a[240:255], a[84:87], v[232:235], a[240:255]
  v_xor_b32 v245, v245, v23
  v_or3_b32 v25, v240, v241, v244
  v_bitop3_b32 v25, v25, v245, s25 bitop3:0xa8
  v_mfma_f32_32x32x16_bf16 v[28:43], a[80:83], v[236:239], v[28:43]
  buffer_load_dwordx4 v[176:179], v1, s[40:43], s81 offen offset:1024 sc1
  v_cmp_ne_u32 vcc, 0, v25
  v_mfma_f32_32x32x16_bf16 v[76:91], a[84:87], v[236:239], v[76:91]
  s_cbranch_vccnz ar_81
ad_82:
  v_mfma_f32_32x32x16_bf16 a[224:239], a[136:139], v[240:243], a[224:239]
  buffer_load_dwordx4 v[180:183], v21, s[40:43], s81 offen offset:1024 sc1
  s_waitcnt vmcnt(16)
  v_xor_b32 v248, v248, v20
  v_xor_b32 v249, v249, v23
  v_xor_b32 v252, v252, v20
  v_mfma_f32_32x32x16_bf16 a[240:255], a[140:143], v[240:243], a[240:255]
  buffer_load_dwordx4 v[184:187], v1, s[40:43], s33 offen offset:1024 sc1
  v_xor_b32 v253, v253, v23
  v_or3_b32 v25, v248, v249, v252
  v_bitop3_b32 v25, v25, v253, s25 bitop3:0xa8
  v_mfma_f32_32x32x16_bf16 v[28:43], a[136:139], v[244:247], v[28:43]
  v_cmp_ne_u32 vcc, 0, v25
  v_mfma_f32_32x32x16_bf16 v[76:91], a[140:143], v[244:247], v[76:91]
  buffer_load_dwordx4 v[188:191], v21, s[40:43], s33 offen offset:1024 sc1
  s_cbranch_vccnz ar_83
ad_84:
  s_waitcnt  lgkmcnt(14)
  v_mfma_f32_32x32x16_bf16 a[224:239], a[192:195], v[248:251], a[224:239]
  s_waitcnt vmcnt(16)
  v_xor_b32 v128, v128, v20
  v_xor_b32 v129, v129, v23
  v_xor_b32 v132, v132, v20
  v_mfma_f32_32x32x16_bf16 a[240:255], a[196:199], v[248:251], a[240:255]
  buffer_load_dwordx4 v[192:195], v1, s[40:43], s77 offen offset:2048 sc1
  v_xor_b32 v133, v133, v23
  v_or3_b32 v25, v128, v129, v132
  v_bitop3_b32 v25, v25, v133, s25 bitop3:0xa8
  v_mfma_f32_32x32x16_bf16 v[28:43], a[192:195], v[252:255], v[28:43]
  v_cmp_ne_u32 vcc, 0, v25
  v_mfma_f32_32x32x16_bf16 v[76:91], a[196:199], v[252:255], v[76:91]
  buffer_load_dwordx4 v[196:199], v1, s[40:43], s79 offen offset:2048 sc1
  s_cbranch_vccnz ar_85
ad_86:
  s_waitcnt lgkmcnt(0)
  s_barrier
  ds_read_b128 v[120:123], v14
  v_mfma_f32_32x32x16_bf16 a[224:239], a[32:35], v[128:131], a[224:239]
  s_waitcnt vmcnt(16)
  v_xor_b32 v136, v136, v20
  v_xor_b32 v137, v137, v23
  v_xor_b32 v140, v140, v20
  v_mfma_f32_32x32x16_bf16 a[240:255], a[36:39], v[128:131], a[240:255]
  buffer_load_dwordx4 v[200:203], v1, s[40:43], s81 offen offset:2048 sc1
  v_xor_b32 v141, v141, v23
  v_or3_b32 v25, v136, v137, v140
  v_bitop3_b32 v25, v25, v141, s25 bitop3:0xa8
  v_mfma_f32_32x32x16_bf16 v[28:43], a[32:35], v[132:135], v[28:43]
  buffer_load_dwordx4 v[204:207], v1, s[40:43], s33 offen offset:2048 sc1
  v_cmp_ne_u32 vcc, 0, v25
  v_mfma_f32_32x32x16_bf16 v[76:91], a[36:39], v[132:135], v[76:91]
  s_cbranch_vccnz ar_87
ad_88:
  v_mfma_f32_32x32x16_bf16 a[224:239], a[88:91], v[136:139], a[224:239]
  buffer_load_dwordx4 v[208:211], v21, s[40:43], s77 offen offset:2048 sc1
  s_waitcnt vmcnt(17)
  v_xor_b32 v144, v144, v20
  v_xor_b32 v145, v145, v23
  v_xor_b32 v148, v148, v20
  v_mfma_f32_32x32x16_bf16 a[240:255], a[92:95], v[136:139], a[240:255]
  v_xor_b32 v149, v149, v23
  v_or3_b32 v25, v144, v145, v148
  v_bitop3_b32 v25, v25, v149, s25 bitop3:0xa8
  s_waitcnt vmcnt(14) lgkmcnt(0)
  v_mfma_f32_32x32x16_bf16 v[28:43], a[88:91], v[140:143], v[28:43]
  buffer_load_dwordx4 v[212:215], v21, s[40:43], s79 offen offset:2048 sc1
  v_cmp_ne_u32 vcc, 0, v25
  v_lshlrev_b32 v96, 16, v4
  v_and_b32 v97, s47, v4
  v_mfma_f32_32x32x16_bf16 v[76:91], a[92:95], v[140:143], v[76:91]
  s_cbranch_vccnz ar_89
ad_90:
  v_lshlrev_b32 v98, 16, v5
  v_and_b32 v99, s47, v5
  v_mfma_f32_32x32x16_bf16 a[224:239], a[144:147], v[144:147], a[224:239]
  buffer_load_dwordx4 v[216:219], v21, s[40:43], s81 offen offset:2048 sc1
  s_waitcnt vmcnt(15)
  v_xor_b32 v152, v152, v20
  v_xor_b32 v153, v153, v23
  v_xor_b32 v156, v156, v20
  v_lshlrev_b32 v100, 16, v6
  v_and_b32 v101, s47, v6
  v_mfma_f32_32x32x16_bf16 a[240:255], a[148:151], v[144:147], a[240:255]
  v_xor_b32 v157, v157, v23
  v_or3_b32 v25, v152, v153, v156
  v_bitop3_b32 v25, v25, v157, s25 bitop3:0xa8
  v_lshlrev_b32 v102, 16, v7
  v_and_b32 v103, s47, v7
  v_mfma_f32_32x32x16_bf16 v[28:43], a[144:147], v[148:151], v[28:43]
  buffer_load_dwordx4 v[220:223], v21, s[40:43], s33 offen offset:2048 sc1
  v_cmp_ne_u32 vcc, 0, v25
  v_lshlrev_b32 v104, 16, v8
  v_and_b32 v105, s47, v8
  v_mfma_f32_32x32x16_bf16 v[76:91], a[148:151], v[148:151], v[76:91]
  s_cbranch_vccnz ar_91
ad_92:
  v_lshlrev_b32 v106, 16, v9
  v_and_b32 v107, s47, v9
  v_mfma_f32_32x32x16_bf16 a[224:239], a[200:203], v[152:155], a[224:239]
  s_waitcnt vmcnt(14)
  v_xor_b32 v160, v160, v20
  v_xor_b32 v161, v161, v23
  v_xor_b32 v164, v164, v20
  v_lshlrev_b32 v108, 16, v10
  v_and_b32 v109, s47, v10
  v_mfma_f32_32x32x16_bf16 a[240:255], a[204:207], v[152:155], a[240:255]
  v_xor_b32 v165, v165, v23
  v_or3_b32 v25, v160, v161, v164
  v_bitop3_b32 v25, v25, v165, s25 bitop3:0xa8
  v_lshlrev_b32 v110, 16, v11
  v_and_b32 v111, s47, v11
  v_mfma_f32_32x32x16_bf16 v[28:43], a[200:203], v[156:159], v[28:43]
  v_cmp_ne_u32 vcc, 0, v25
  s_mov_b32 s30, 0x5f800000
  v_lshlrev_b32 v112, 16, v120
  v_mfma_f32_32x32x16_bf16 v[76:91], a[204:207], v[156:159], v[76:91]
  s_cbranch_vccnz ar_93
ad_94:
  v_and_b32 v113, s47, v120
  v_lshlrev_b32 v114, 16, v121
  v_mfma_f32_32x32x16_bf16 a[224:239], a[40:43], v[160:163], a[224:239]
  s_waitcnt vmcnt(12)
  v_xor_b32 v168, v168, v20
  v_xor_b32 v169, v169, v23
  v_xor_b32 v172, v172, v20
  v_and_b32 v115, s47, v121
  v_lshlrev_b32 v116, 16, v122
  v_and_b32 v117, s47, v122
  v_mfma_f32_32x32x16_bf16 a[240:255], a[44:47], v[160:163], a[240:255]
  v_xor_b32 v173, v173, v23
  v_or3_b32 v25, v168, v169, v172
  v_bitop3_b32 v25, v25, v173, s25 bitop3:0xa8
  v_lshlrev_b32 v118, 16, v123
  v_and_b32 v119, s47, v123
  v_mul_f32 v112, s30, v112
  v_mfma_f32_32x32x16_bf16 v[28:43], a[40:43], v[164:167], v[28:43]
  v_cmp_ne_u32 vcc, 0, v25
  v_mul_f32 v113, s30, v113
  v_mul_f32 v114, s30, v114
  v_mul_f32 v115, s30, v115
  v_mfma_f32_32x32x16_bf16 v[76:91], a[44:47], v[164:167], v[76:91]
  s_cbranch_vccnz ar_95
ad_96:
  v_mul_f32 v116, s30, v116
  v_mul_f32 v117, s30, v117
  v_mul_f32 v118, s30, v118
  v_mfma_f32_32x32x16_bf16 a[224:239], a[96:99], v[168:171], a[224:239]
  s_waitcnt vmcnt(10)
  v_xor_b32 v176, v176, v20
  v_xor_b32 v177, v177, v23
  v_xor_b32 v180, v180, v20
  v_mul_f32 v119, s30, v119
  v_mfma_f32_32x32x16_bf16 a[240:255], a[100:103], v[168:171], a[240:255]
  v_xor_b32 v181, v181, v23
  v_or3_b32 v25, v176, v177, v180
  v_bitop3_b32 v25, v25, v181, s25 bitop3:0xa8
  v_mfma_f32_32x32x16_bf16 v[28:43], a[96:99], v[172:175], v[28:43]
  v_cmp_ne_u32 vcc, 0, v25
  v_mfma_f32_32x32x16_bf16 v[76:91], a[100:103], v[172:175], v[76:91]
  s_cbranch_vccnz ar_97
ad_98:
  v_mfma_f32_32x32x16_bf16 a[224:239], a[152:155], v[176:179], a[224:239]
  s_waitcnt vmcnt(8)
  v_xor_b32 v184, v184, v20
  v_xor_b32 v185, v185, v23
  v_xor_b32 v188, v188, v20
  v_xor_b32 v189, v189, v23
  v_or3_b32 v25, v184, v185, v188
  v_bitop3_b32 v25, v25, v189, s25 bitop3:0xa8
  v_cmp_ne_u32 vcc, 0, v25
  s_cbranch_vccnz ar_99
ad_100:
  v_mfma_f32_32x32x16_bf16 a[224:239], a[208:211], v[184:187], a[224:239]
  s_waitcnt vmcnt(6)
  v_xor_b32 v192, v192, v20
  v_xor_b32 v193, v193, v23
  v_xor_b32 v196, v196, v20
  v_xor_b32 v197, v197, v23
  v_or3_b32 v25, v192, v193, v196
  v_bitop3_b32 v25, v25, v197, s25 bitop3:0xa8
  v_cmp_ne_u32 vcc, 0, v25
  s_cbranch_vccnz ar_101
ad_102:
  v_mfma_f32_32x32x16_bf16 a[224:239], a[48:51], v[192:195], a[224:239]
  s_waitcnt vmcnt(4)
  v_xor_b32 v200, v200, v20
  v_xor_b32 v201, v201, v23
  v_xor_b32 v204, v204, v20
  v_mfma_f32_32x32x16_bf16 a[224:239], a[104:107], v[196:199], a[224:239]
  v_xor_b32 v205, v205, v23
  v_or3_b32 v25, v200, v201, v204
  v_bitop3_b32 v25, v25, v205, s25 bitop3:0xa8
  v_cmp_ne_u32 vcc, 0, v25
  s_cbranch_vccnz ar_103
ad_104:
  v_mfma_f32_32x32x16_bf16 a[224:239], a[160:163], v[200:203], a[224:239]
  v_mfma_f32_32x32x16_bf16 a[224:239], a[216:219], v[204:207], a[224:239]
  s_nop 4
  v_mfma_f32_32x32x16_bf16 a[240:255], a[156:159], v[176:179], a[240:255]
  s_nop 4
  v_mfma_f32_32x32x16_bf16 a[240:255], a[212:215], v[184:187], a[240:255]
  ds_write_b128 v12, a[224:227] offset:0
  v_mfma_f32_32x32x16_bf16 a[240:255], a[52:55], v[192:195], a[240:255]
  s_waitcnt vmcnt(2)
  v_xor_b32 v208, v208, v20
  v_xor_b32 v209, v209, v23
  v_xor_b32 v212, v212, v20
  ds_write_b128 v12, a[228:231] offset:576
  v_mfma_f32_32x32x16_bf16 a[240:255], a[108:111], v[196:199], a[240:255]
  v_xor_b32 v213, v213, v23
  v_or3_b32 v25, v208, v209, v212
  v_bitop3_b32 v25, v25, v213, s25 bitop3:0xa8
  ds_write_b128 v12, a[232:235] offset:1152
  v_mfma_f32_32x32x16_bf16 a[240:255], a[164:167], v[200:203], a[240:255]
  v_cmp_ne_u32 vcc, 0, v25
  ds_write_b128 v12, a[236:239] offset:1728
  v_mfma_f32_32x32x16_bf16 a[240:255], a[220:223], v[204:207], a[240:255]
  s_cbranch_vccnz ar_105
ad_106:
  s_nop 4
  v_mfma_f32_32x32x16_bf16 v[28:43], a[152:155], v[180:183], v[28:43]
  s_waitcnt vmcnt(0)
  v_xor_b32 v216, v216, v20
  v_xor_b32 v217, v217, v23
  v_xor_b32 v220, v220, v20
  s_nop 0
  ds_write_b128 v12, a[240:243] offset:2304
  v_mfma_f32_32x32x16_bf16 v[28:43], a[208:211], v[188:191], v[28:43]
  v_xor_b32 v221, v221, v23
  v_or3_b32 v25, v216, v217, v220
  v_bitop3_b32 v25, v25, v221, s25 bitop3:0xa8
  ds_write_b128 v12, a[244:247] offset:2880
  v_mfma_f32_32x32x16_bf16 v[28:43], a[48:51], v[208:211], v[28:43]
  v_cmp_ne_u32 vcc, 0, v25
  ds_write_b128 v12, a[248:251] offset:3456
  v_mfma_f32_32x32x16_bf16 v[28:43], a[104:107], v[212:215], v[28:43]
  s_cbranch_vccnz ar_107
ad_108:
  ds_write_b128 v12, a[252:255] offset:4032
  v_mfma_f32_32x32x16_bf16 v[28:43], a[160:163], v[216:219], v[28:43]
  s_waitcnt lgkmcnt(0)
  s_barrier
  s_nop 0
  ds_read_b128 v[44:47], v13 offset:0
  ds_read_b128 v[48:51], v13 offset:18432
  ds_read_b128 v[52:55], v15 offset:0
  ds_read_b128 v[56:59], v15 offset:18432
  ds_read_b128 v[60:63], v13 offset:4608
  ds_read_b128 v[64:67], v13 offset:23040
  ds_read_b128 v[68:71], v15 offset:4608
  ds_read_b128 v[72:75], v15 offset:23040
  v_mfma_f32_32x32x16_bf16 v[28:43], a[216:219], v[220:223], v[28:43]
  s_nop 4
  v_mfma_f32_32x32x16_bf16 v[76:91], a[156:159], v[180:183], v[76:91]
  s_nop 4
  v_mfma_f32_32x32x16_bf16 v[76:91], a[212:215], v[188:191], v[76:91]
  ds_write_b128 v12, v[28:31] offset:9216
  v_mfma_f32_32x32x16_bf16 v[76:91], a[52:55], v[208:211], v[76:91]
  ds_write_b128 v12, v[32:35] offset:9792
  v_mfma_f32_32x32x16_bf16 v[76:91], a[108:111], v[212:215], v[76:91]
  ds_write_b128 v12, v[36:39] offset:10368
  v_mfma_f32_32x32x16_bf16 v[76:91], a[164:167], v[216:219], v[76:91]
  ds_write_b128 v12, v[40:43] offset:10944
  v_mfma_f32_32x32x16_bf16 v[76:91], a[220:223], v[220:223], v[76:91]
  s_waitcnt lgkmcnt(8)
  s_nop 0
  v_pk_add_f32 v[44:45], v[44:45], v[48:49]
  v_pk_add_f32 v[52:53], v[52:53], v[56:57]
  v_pk_add_f32 v[46:47], v[46:47], v[50:51]
  v_pk_add_f32 v[54:55], v[54:55], v[58:59]
  v_pk_add_f32 v[44:45], v[44:45], v[52:53]
  v_pk_add_f32 v[46:47], v[46:47], v[54:55]
  v_pk_fma_f32 v[44:45], v[44:45], v[112:113], v[96:97]
  v_pk_fma_f32 v[46:47], v[46:47], v[114:115], v[98:99]
  v_cvt_pk_bf16_f32 v16, v44, v45
  v_cvt_pk_bf16_f32 v17, v46, v47
  s_waitcnt lgkmcnt(4)
  s_nop 0
  ds_write_b128 v12, v[76:79] offset:11520
  ds_write_b128 v12, v[80:83] offset:12096
  ds_write_b128 v12, v[84:87] offset:12672
  ds_write_b128 v12, v[88:91] offset:13248
  v_pk_add_f32 v[60:61], v[60:61], v[64:65]
  v_pk_add_f32 v[68:69], v[68:69], v[72:73]
  v_pk_add_f32 v[62:63], v[62:63], v[66:67]
  v_pk_add_f32 v[70:71], v[70:71], v[74:75]
  v_pk_add_f32 v[60:61], v[60:61], v[68:69]
  v_pk_add_f32 v[62:63], v[62:63], v[70:71]
  v_pk_fma_f32 v[60:61], v[60:61], v[116:117], v[100:101]
  v_pk_fma_f32 v[62:63], v[62:63], v[118:119], v[102:103]
  v_cvt_pk_bf16_f32 v18, v60, v61
  v_cvt_pk_bf16_f32 v19, v62, v63
  global_store_dwordx4 v22, v[16:19], s[34:35] sc1
  s_waitcnt lgkmcnt(0)
  s_barrier
  ds_read_b128 v[128:131], v13 offset:9216
  ds_read_b128 v[132:135], v13 offset:27648
  ds_read_b128 v[136:139], v15 offset:9216
  ds_read_b128 v[140:143], v15 offset:27648
  ds_read_b128 v[144:147], v13 offset:13824
  ds_read_b128 v[148:151], v13 offset:32256
  ds_read_b128 v[152:155], v15 offset:13824
  ds_read_b128 v[156:159], v15 offset:32256
  s_waitcnt lgkmcnt(4)
  s_nop 0
  v_pk_add_f32 v[128:129], v[128:129], v[132:133]
  v_pk_add_f32 v[136:137], v[136:137], v[140:141]
  v_pk_add_f32 v[130:131], v[130:131], v[134:135]
  v_pk_add_f32 v[138:139], v[138:139], v[142:143]
  v_pk_add_f32 v[128:129], v[128:129], v[136:137]
  v_pk_add_f32 v[130:131], v[130:131], v[138:139]
  v_pk_fma_f32 v[128:129], v[128:129], v[112:113], v[104:105]
  v_pk_fma_f32 v[130:131], v[130:131], v[114:115], v[106:107]
  v_cvt_pk_bf16_f32 v4, v128, v129
  v_cvt_pk_bf16_f32 v5, v130, v131
  s_waitcnt lgkmcnt(0)
  s_nop 0
  v_pk_add_f32 v[144:145], v[144:145], v[148:149]
  v_pk_add_f32 v[152:153], v[152:153], v[156:157]
  v_pk_add_f32 v[146:147], v[146:147], v[150:151]
  v_pk_add_f32 v[154:155], v[154:155], v[158:159]
  v_pk_add_f32 v[144:145], v[144:145], v[152:153]
  v_pk_add_f32 v[146:147], v[146:147], v[154:155]
  v_pk_fma_f32 v[144:145], v[144:145], v[116:117], v[108:109]
  v_pk_fma_f32 v[146:147], v[146:147], v[118:119], v[110:111]
  v_cvt_pk_bf16_f32 v6, v144, v145
  v_cvt_pk_bf16_f32 v7, v146, v147
  global_store_dwordx4 v22, v[4:7], s[60:61] sc1
  s_or_b32 s0, s44, s45
  s_cbranch_scc1 L_noep
  s_mov_b32 exec_hi, 0
  buffer_store_dword v2, v127, s[40:43], s0 offen sc1
  s_mov_b32 exec_hi, -1
L_noep:
  s_endpgm
L_e1retry:
  s_sub_u32 s48, s48, 1
  s_cbranch_scc1 L_end
  s_wqm_b64 exec, s[56:57]
  buffer_load_dwordx2 v[28:29], v64, s[40:43], s4 offen sc1
  buffer_load_dwordx2 v[30:31], v64, s[40:43], s5 offen sc1
  buffer_load_dwordx2 v[32:33], v64, s[40:43], s6 offen sc1
  buffer_load_dwordx2 v[34:35], v64, s[40:43], s7 offen sc1
  buffer_load_dwordx4 v[84:87], v115, s[40:43], s8 offen sc1
  buffer_load_dwordx4 v[88:91], v115, s[40:43], s9 offen sc1
  s_mov_b64 exec, -1
  s_waitcnt vmcnt(0)
  s_branch L_e1chk
retry_2:
  s_sub_u32 s48, s48, 1
  s_cbranch_scc1 L_end
  buffer_load_dword v55, v54, s[40:43], 0 offen sc1
  s_waitcnt vmcnt(0)
  s_branch chk_1
L_zretry:
  s_sub_u32 s48, s48, 1
  s_cbranch_scc1 L_end
  s_wqm_b64 exec, s[56:57]
  buffer_load_dwordx4 v[72:75], v28, s[40:43], s58 offen sc1
  buffer_load_dwordx4 v[76:79], v28, s[40:43], s59 offen sc1
  buffer_load_dwordx4 v[80:83], v28, s[40:43], s60 offen sc1
  buffer_load_dwordx4 v[84:87], v28, s[40:43], s61 offen sc1
  buffer_load_dwordx4 v[32:35], v1, s[40:43], s66 offen sc1
  s_mov_b64 exec, -1
  s_waitcnt vmcnt(0)
  s_branch L_zchk
xr_4:
  s_sub_u32 s48, s48, 1
  s_cbranch_scc1 L_end
  buffer_load_dwordx4 v[128:131], v25, s[40:43], s68 offen offset:0 sc1
  buffer_load_dwordx4 v[132:135], v25, s[40:43], s70 offen offset:0 sc1
  s_waitcnt vmcnt(0)
  v_xor_b32 v128, v128, v14
  v_xor_b32 v129, v129, v15
  v_xor_b32 v132, v132, v14
  v_xor_b32 v133, v133, v15
  v_or3_b32 v13, v128, v129, v132
  v_bitop3_b32 v13, v13, v133, s25 bitop3:0xa8
  v_cmp_ne_u32_e64 vcc, 0, v13
  s_cmp_lg_u64 vcc, 0
  s_cbranch_scc1 xr_4
  buffer_load_dwordx4 v[136:139], v25, s[40:43], s72 offen offset:0 sc1
  buffer_load_dwordx4 v[140:143], v25, s[40:43], s74 offen offset:0 sc1
  buffer_load_dwordx4 v[144:147], v25, s[40:43], s68 offen offset:1024 sc1
  buffer_load_dwordx4 v[148:151], v25, s[40:43], s70 offen offset:1024 sc1
  buffer_load_dwordx4 v[152:155], v25, s[40:43], s72 offen offset:1024 sc1
  buffer_load_dwordx4 v[156:159], v25, s[40:43], s74 offen offset:1024 sc1
  buffer_load_dwordx4 v[160:163], v25, s[40:43], s68 offen offset:2048 sc1
  buffer_load_dwordx4 v[164:167], v25, s[40:43], s70 offen offset:2048 sc1
  buffer_load_dwordx4 v[168:171], v25, s[40:43], s72 offen offset:2048 sc1
  s_branch xd_5
xr_7:
  s_sub_u32 s48, s48, 1
  s_cbranch_scc1 L_end
  buffer_load_dwordx4 v[136:139], v25, s[40:43], s72 offen offset:0 sc1
  buffer_load_dwordx4 v[140:143], v25, s[40:43], s74 offen offset:0 sc1
  s_waitcnt vmcnt(0)
  v_xor_b32 v136, v136, v14
  v_xor_b32 v137, v137, v15
  v_xor_b32 v140, v140, v14
  v_xor_b32 v141, v141, v15
  v_or3_b32 v13, v136, v137, v140
  v_bitop3_b32 v13, v13, v141, s25 bitop3:0xa8
  v_cmp_ne_u32_e64 vcc, 0, v13
  s_cmp_lg_u64 vcc, 0
  s_cbranch_scc1 xr_7
  buffer_load_dwordx4 v[144:147], v25, s[40:43], s68 offen offset:1024 sc1
  buffer_load_dwordx4 v[148:151], v25, s[40:43], s70 offen offset:1024 sc1
  buffer_load_dwordx4 v[152:155], v25, s[40:43], s72 offen offset:1024 sc1
  buffer_load_dwordx4 v[156:159], v25, s[40:43], s74 offen offset:1024 sc1
  buffer_load_dwordx4 v[160:163], v25, s[40:43], s68 offen offset:2048 sc1
  buffer_load_dwordx4 v[164:167], v25, s[40:43], s70 offen offset:2048 sc1
  buffer_load_dwordx4 v[168:171], v25, s[40:43], s72 offen offset:2048 sc1
  buffer_load_dwordx4 v[172:175], v25, s[40:43], s74 offen offset:2048 sc1
  buffer_load_dwordx4 v[176:179], v25, s[40:43], s68 offen offset:3072 sc1
  s_branch xd_8
xr_10:
  s_sub_u32 s48, s48, 1
  s_cbranch_scc1 L_end
  buffer_load_dwordx4 v[144:147], v25, s[40:43], s68 offen offset:1024 sc1
  buffer_load_dwordx4 v[148:151], v25, s[40:43], s70 offen offset:1024 sc1
  s_waitcnt vmcnt(0)
  v_xor_b32 v144, v144, v14
  v_xor_b32 v145, v145, v15
  v_xor_b32 v148, v148, v14
  v_xor_b32 v149, v149, v15
  v_or3_b32 v13, v144, v145, v148
  v_bitop3_b32 v13, v13, v149, s25 bitop3:0xa8
  v_cmp_ne_u32_e64 vcc, 0, v13
  s_cmp_lg_u64 vcc, 0
  s_cbranch_scc1 xr_10
  buffer_load_dwordx4 v[152:155], v25, s[40:43], s72 offen offset:1024 sc1
  buffer_load_dwordx4 v[156:159], v25, s[40:43], s74 offen offset:1024 sc1
  buffer_load_dwordx4 v[160:163], v25, s[40:43], s68 offen offset:2048 sc1
  buffer_load_dwordx4 v[164:167], v25, s[40:43], s70 offen offset:2048 sc1
  buffer_load_dwordx4 v[168:171], v25, s[40:43], s72 offen offset:2048 sc1
  buffer_load_dwordx4 v[172:175], v25, s[40:43], s74 offen offset:2048 sc1
  buffer_load_dwordx4 v[176:179], v25, s[40:43], s68 offen offset:3072 sc1
  buffer_load_dwordx4 v[180:183], v25, s[40:43], s70 offen offset:3072 sc1
  buffer_load_dwordx4 v[184:187], v25, s[40:43], s72 offen offset:3072 sc1
  s_branch xd_11
xr_13:
  s_sub_u32 s48, s48, 1
  s_cbranch_scc1 L_end
  buffer_load_dwordx4 v[152:155], v25, s[40:43], s72 offen offset:1024 sc1
  buffer_load_dwordx4 v[156:159], v25, s[40:43], s74 offen offset:1024 sc1
  s_waitcnt vmcnt(0)
  v_xor_b32 v152, v152, v14
  v_xor_b32 v153, v153, v15
  v_xor_b32 v156, v156, v14
  v_xor_b32 v157, v157, v15
  v_or3_b32 v13, v152, v153, v156
  v_bitop3_b32 v13, v13, v157, s25 bitop3:0xa8
  v_cmp_ne_u32_e64 vcc, 0, v13
  s_cmp_lg_u64 vcc, 0
  s_cbranch_scc1 xr_13
  buffer_load_dwordx4 v[160:163], v25, s[40:43], s68 offen offset:2048 sc1
  buffer_load_dwordx4 v[164:167], v25, s[40:43], s70 offen offset:2048 sc1
  buffer_load_dwordx4 v[168:171], v25, s[40:43], s72 offen offset:2048 sc1
  buffer_load_dwordx4 v[172:175], v25, s[40:43], s74 offen offset:2048 sc1
  buffer_load_dwordx4 v[176:179], v25, s[40:43], s68 offen offset:3072 sc1
  buffer_load_dwordx4 v[180:183], v25, s[40:43], s70 offen offset:3072 sc1
  buffer_load_dwordx4 v[184:187], v25, s[40:43], s72 offen offset:3072 sc1
  buffer_load_dwordx4 v[188:191], v25, s[40:43], s74 offen offset:3072 sc1
  buffer_load_dwordx4 v[192:195], v25, s[40:43], s69 offen offset:0 sc1
  s_branch xd_14
xr_16:
  s_sub_u32 s48, s48, 1
  s_cbranch_scc1 L_end
  buffer_load_dwordx4 v[160:163], v25, s[40:43], s68 offen offset:2048 sc1
  buffer_load_dwordx4 v[164:167], v25, s[40:43], s70 offen offset:2048 sc1
  s_waitcnt vmcnt(0)
  v_xor_b32 v160, v160, v14
  v_xor_b32 v161, v161, v15
  v_xor_b32 v164, v164, v14
  v_xor_b32 v165, v165, v15
  v_or3_b32 v13, v160, v161, v164
  v_bitop3_b32 v13, v13, v165, s25 bitop3:0xa8
  v_cmp_ne_u32_e64 vcc, 0, v13
  s_cmp_lg_u64 vcc, 0
  s_cbranch_scc1 xr_16
  buffer_load_dwordx4 v[168:171], v25, s[40:43], s72 offen offset:2048 sc1
  buffer_load_dwordx4 v[172:175], v25, s[40:43], s74 offen offset:2048 sc1
  buffer_load_dwordx4 v[176:179], v25, s[40:43], s68 offen offset:3072 sc1
  buffer_load_dwordx4 v[180:183], v25, s[40:43], s70 offen offset:3072 sc1
  buffer_load_dwordx4 v[184:187], v25, s[40:43], s72 offen offset:3072 sc1
  buffer_load_dwordx4 v[188:191], v25, s[40:43], s74 offen offset:3072 sc1
  buffer_load_dwordx4 v[192:195], v25, s[40:43], s69 offen offset:0 sc1
  buffer_load_dwordx4 v[196:199], v25, s[40:43], s71 offen offset:0 sc1
  buffer_load_dwordx4 v[200:203], v25, s[40:43], s73 offen offset:0 sc1
  s_branch xd_17
xr_19:
  s_sub_u32 s48, s48, 1
  s_cbranch_scc1 L_end
  buffer_load_dwordx4 v[168:171], v25, s[40:43], s72 offen offset:2048 sc1
  buffer_load_dwordx4 v[172:175], v25, s[40:43], s74 offen offset:2048 sc1
  s_waitcnt vmcnt(0)
  v_xor_b32 v168, v168, v14
  v_xor_b32 v169, v169, v15
  v_xor_b32 v172, v172, v14
  v_xor_b32 v173, v173, v15
  v_or3_b32 v13, v168, v169, v172
  v_bitop3_b32 v13, v13, v173, s25 bitop3:0xa8
  v_cmp_ne_u32_e64 vcc, 0, v13
  s_cmp_lg_u64 vcc, 0
  s_cbranch_scc1 xr_19
  buffer_load_dwordx4 v[176:179], v25, s[40:43], s68 offen offset:3072 sc1
  buffer_load_dwordx4 v[180:183], v25, s[40:43], s70 offen offset:3072 sc1
  buffer_load_dwordx4 v[184:187], v25, s[40:43], s72 offen offset:3072 sc1
  buffer_load_dwordx4 v[188:191], v25, s[40:43], s74 offen offset:3072 sc1
  buffer_load_dwordx4 v[192:195], v25, s[40:43], s69 offen offset:0 sc1
  buffer_load_dwordx4 v[196:199], v25, s[40:43], s71 offen offset:0 sc1
  buffer_load_dwordx4 v[200:203], v25, s[40:43], s73 offen offset:0 sc1
  buffer_load_dwordx4 v[204:207], v25, s[40:43], s75 offen offset:0 sc1
  buffer_load_dwordx4 v[208:211], v25, s[40:43], s69 offen offset:1024 sc1
  s_branch xd_20
xr_22:
  s_sub_u32 s48, s48, 1
  s_cbranch_scc1 L_end
  buffer_load_dwordx4 v[176:179], v25, s[40:43], s68 offen offset:3072 sc1
  buffer_load_dwordx4 v[180:183], v25, s[40:43], s70 offen offset:3072 sc1
  s_waitcnt vmcnt(0)
  v_xor_b32 v176, v176, v14
  v_xor_b32 v177, v177, v15
  v_xor_b32 v180, v180, v14
  v_xor_b32 v181, v181, v15
  v_or3_b32 v13, v176, v177, v180
  v_bitop3_b32 v13, v13, v181, s25 bitop3:0xa8
  v_cmp_ne_u32_e64 vcc, 0, v13
  s_cmp_lg_u64 vcc, 0
  s_cbranch_scc1 xr_22
  buffer_load_dwordx4 v[184:187], v25, s[40:43], s72 offen offset:3072 sc1
  buffer_load_dwordx4 v[188:191], v25, s[40:43], s74 offen offset:3072 sc1
  buffer_load_dwordx4 v[192:195], v25, s[40:43], s69 offen offset:0 sc1
  buffer_load_dwordx4 v[196:199], v25, s[40:43], s71 offen offset:0 sc1
  buffer_load_dwordx4 v[200:203], v25, s[40:43], s73 offen offset:0 sc1
  buffer_load_dwordx4 v[204:207], v25, s[40:43], s75 offen offset:0 sc1
  buffer_load_dwordx4 v[208:211], v25, s[40:43], s69 offen offset:1024 sc1
  buffer_load_dwordx4 v[212:215], v25, s[40:43], s71 offen offset:1024 sc1
  buffer_load_dwordx4 v[216:219], v25, s[40:43], s73 offen offset:1024 sc1
  s_branch xd_23
xr_25:
  s_sub_u32 s48, s48, 1
  s_cbranch_scc1 L_end
  buffer_load_dwordx4 v[184:187], v25, s[40:43], s72 offen offset:3072 sc1
  buffer_load_dwordx4 v[188:191], v25, s[40:43], s74 offen offset:3072 sc1
  s_waitcnt vmcnt(0)
  v_xor_b32 v184, v184, v14
  v_xor_b32 v185, v185, v15
  v_xor_b32 v188, v188, v14
  v_xor_b32 v189, v189, v15
  v_or3_b32 v13, v184, v185, v188
  v_bitop3_b32 v13, v13, v189, s25 bitop3:0xa8
  v_cmp_ne_u32_e64 vcc, 0, v13
  s_cmp_lg_u64 vcc, 0
  s_cbranch_scc1 xr_25
  buffer_load_dwordx4 v[192:195], v25, s[40:43], s69 offen offset:0 sc1
  buffer_load_dwordx4 v[196:199], v25, s[40:43], s71 offen offset:0 sc1
  buffer_load_dwordx4 v[200:203], v25, s[40:43], s73 offen offset:0 sc1
  buffer_load_dwordx4 v[204:207], v25, s[40:43], s75 offen offset:0 sc1
  buffer_load_dwordx4 v[208:211], v25, s[40:43], s69 offen offset:1024 sc1
  buffer_load_dwordx4 v[212:215], v25, s[40:43], s71 offen offset:1024 sc1
  buffer_load_dwordx4 v[216:219], v25, s[40:43], s73 offen offset:1024 sc1
  buffer_load_dwordx4 v[220:223], v25, s[40:43], s75 offen offset:1024 sc1
  buffer_load_dwordx4 v[224:227], v25, s[40:43], s69 offen offset:2048 sc1
  s_branch xd_26
xr_28:
  s_sub_u32 s48, s48, 1
  s_cbranch_scc1 L_end
  buffer_load_dwordx4 v[192:195], v25, s[40:43], s69 offen offset:0 sc1
  buffer_load_dwordx4 v[196:199], v25, s[40:43], s71 offen offset:0 sc1
  s_waitcnt vmcnt(0)
  v_xor_b32 v192, v192, v14
  v_xor_b32 v193, v193, v15
  v_xor_b32 v196, v196, v14
  v_xor_b32 v197, v197, v15
  v_or3_b32 v13, v192, v193, v196
  v_bitop3_b32 v13, v13, v197, s25 bitop3:0xa8
  v_cmp_ne_u32_e64 vcc, 0, v13
  s_cmp_lg_u64 vcc, 0
  s_cbranch_scc1 xr_28
  buffer_load_dwordx4 v[200:203], v25, s[40:43], s73 offen offset:0 sc1
  buffer_load_dwordx4 v[204:207], v25, s[40:43], s75 offen offset:0 sc1
  buffer_load_dwordx4 v[208:211], v25, s[40:43], s69 offen offset:1024 sc1
  buffer_load_dwordx4 v[212:215], v25, s[40:43], s71 offen offset:1024 sc1
  buffer_load_dwordx4 v[216:219], v25, s[40:43], s73 offen offset:1024 sc1
  buffer_load_dwordx4 v[220:223], v25, s[40:43], s75 offen offset:1024 sc1
  buffer_load_dwordx4 v[224:227], v25, s[40:43], s69 offen offset:2048 sc1
  buffer_load_dwordx4 v[228:231], v25, s[40:43], s71 offen offset:2048 sc1
  buffer_load_dwordx4 v[232:235], v25, s[40:43], s73 offen offset:2048 sc1
  s_branch xd_29
xr_31:
  s_sub_u32 s48, s48, 1
  s_cbranch_scc1 L_end
  buffer_load_dwordx4 v[200:203], v25, s[40:43], s73 offen offset:0 sc1
  buffer_load_dwordx4 v[204:207], v25, s[40:43], s75 offen offset:0 sc1
  s_waitcnt vmcnt(0)
  v_xor_b32 v200, v200, v14
  v_xor_b32 v201, v201, v15
  v_xor_b32 v204, v204, v14
  v_xor_b32 v205, v205, v15
  v_or3_b32 v13, v200, v201, v204
  v_bitop3_b32 v13, v13, v205, s25 bitop3:0xa8
  v_cmp_ne_u32_e64 vcc, 0, v13
  s_cmp_lg_u64 vcc, 0
  s_cbranch_scc1 xr_31
  buffer_load_dwordx4 v[208:211], v25, s[40:43], s69 offen offset:1024 sc1
  buffer_load_dwordx4 v[212:215], v25, s[40:43], s71 offen offset:1024 sc1
  buffer_load_dwordx4 v[216:219], v25, s[40:43], s73 offen offset:1024 sc1
  buffer_load_dwordx4 v[220:223], v25, s[40:43], s75 offen offset:1024 sc1
  buffer_load_dwordx4 v[224:227], v25, s[40:43], s69 offen offset:2048 sc1
  buffer_load_dwordx4 v[228:231], v25, s[40:43], s71 offen offset:2048 sc1
  buffer_load_dwordx4 v[232:235], v25, s[40:43], s73 offen offset:2048 sc1
  buffer_load_dwordx4 v[236:239], v25, s[40:43], s75 offen offset:2048 sc1
  buffer_load_dwordx4 v[240:243], v25, s[40:43], s69 offen offset:3072 sc1
  s_branch xd_32
xr_34:
  s_sub_u32 s48, s48, 1
  s_cbranch_scc1 L_end
  buffer_load_dwordx4 v[208:211], v25, s[40:43], s69 offen offset:1024 sc1
  buffer_load_dwordx4 v[212:215], v25, s[40:43], s71 offen offset:1024 sc1
  s_waitcnt vmcnt(0)
  v_xor_b32 v208, v208, v14
  v_xor_b32 v209, v209, v15
  v_xor_b32 v212, v212, v14
  v_xor_b32 v213, v213, v15
  v_or3_b32 v13, v208, v209, v212
  v_bitop3_b32 v13, v13, v213, s25 bitop3:0xa8
  v_cmp_ne_u32_e64 vcc, 0, v13
  s_cmp_lg_u64 vcc, 0
  s_cbranch_scc1 xr_34
  buffer_load_dwordx4 v[216:219], v25, s[40:43], s73 offen offset:1024 sc1
  buffer_load_dwordx4 v[220:223], v25, s[40:43], s75 offen offset:1024 sc1
  buffer_load_dwordx4 v[224:227], v25, s[40:43], s69 offen offset:2048 sc1
  buffer_load_dwordx4 v[228:231], v25, s[40:43], s71 offen offset:2048 sc1
  buffer_load_dwordx4 v[232:235], v25, s[40:43], s73 offen offset:2048 sc1
  buffer_load_dwordx4 v[236:239], v25, s[40:43], s75 offen offset:2048 sc1
  buffer_load_dwordx4 v[240:243], v25, s[40:43], s69 offen offset:3072 sc1
  buffer_load_dwordx4 v[244:247], v25, s[40:43], s71 offen offset:3072 sc1
  buffer_load_dwordx4 v[248:251], v25, s[40:43], s73 offen offset:3072 sc1
  s_branch xd_35
xr_37:
  s_sub_u32 s48, s48, 1
  s_cbranch_scc1 L_end
  buffer_load_dwordx4 v[216:219], v25, s[40:43], s73 offen offset:1024 sc1
  buffer_load_dwordx4 v[220:223], v25, s[40:43], s75 offen offset:1024 sc1
  s_waitcnt vmcnt(0)
  v_xor_b32 v216, v216, v14
  v_xor_b32 v217, v217, v15
  v_xor_b32 v220, v220, v14
  v_xor_b32 v221, v221, v15
  v_or3_b32 v13, v216, v217, v220
  v_bitop3_b32 v13, v13, v221, s25 bitop3:0xa8
  v_cmp_ne_u32_e64 vcc, 0, v13
  s_cmp_lg_u64 vcc, 0
  s_cbranch_scc1 xr_37
  buffer_load_dwordx4 v[224:227], v25, s[40:43], s69 offen offset:2048 sc1
  buffer_load_dwordx4 v[228:231], v25, s[40:43], s71 offen offset:2048 sc1
  buffer_load_dwordx4 v[232:235], v25, s[40:43], s73 offen offset:2048 sc1
  buffer_load_dwordx4 v[236:239], v25, s[40:43], s75 offen offset:2048 sc1
  buffer_load_dwordx4 v[240:243], v25, s[40:43], s69 offen offset:3072 sc1
  buffer_load_dwordx4 v[244:247], v25, s[40:43], s71 offen offset:3072 sc1
  buffer_load_dwordx4 v[248:251], v25, s[40:43], s73 offen offset:3072 sc1
  buffer_load_dwordx4 v[252:255], v25, s[40:43], s75 offen offset:3072 sc1
  s_waitcnt vmcnt(0)
  s_branch xd_38
xr_40:
  s_sub_u32 s48, s48, 1
  s_cbranch_scc1 L_end
  buffer_load_dwordx4 v[224:227], v25, s[40:43], s69 offen offset:2048 sc1
  buffer_load_dwordx4 v[228:231], v25, s[40:43], s71 offen offset:2048 sc1
  s_waitcnt vmcnt(0)
  v_xor_b32 v224, v224, v14
  v_xor_b32 v225, v225, v15
  v_xor_b32 v228, v228, v14
  v_xor_b32 v229, v229, v15
  v_or3_b32 v13, v224, v225, v228
  v_bitop3_b32 v13, v13, v229, s25 bitop3:0xa8
  v_cmp_ne_u32 vcc, 0, v13
  s_cmp_lg_u64 vcc, 0
  s_cbranch_scc1 xr_40
  buffer_load_dwordx4 v[232:235], v25, s[40:43], s73 offen offset:2048 sc1
  buffer_load_dwordx4 v[236:239], v25, s[40:43], s75 offen offset:2048 sc1
  buffer_load_dwordx4 v[240:243], v25, s[40:43], s69 offen offset:3072 sc1
  buffer_load_dwordx4 v[244:247], v25, s[40:43], s71 offen offset:3072 sc1
  buffer_load_dwordx4 v[248:251], v25, s[40:43], s73 offen offset:3072 sc1
  buffer_load_dwordx4 v[252:255], v25, s[40:43], s75 offen offset:3072 sc1
  s_waitcnt vmcnt(0)
  s_branch xd_41
xr_43:
  s_sub_u32 s48, s48, 1
  s_cbranch_scc1 L_end
  buffer_load_dwordx4 v[232:235], v25, s[40:43], s73 offen offset:2048 sc1
  buffer_load_dwordx4 v[236:239], v25, s[40:43], s75 offen offset:2048 sc1
  s_waitcnt vmcnt(0)
  v_xor_b32 v232, v232, v14
  v_xor_b32 v233, v233, v15
  v_xor_b32 v236, v236, v14
  v_xor_b32 v237, v237, v15
  v_or3_b32 v13, v232, v233, v236
  v_bitop3_b32 v13, v13, v237, s25 bitop3:0xa8
  v_cmp_ne_u32 vcc, 0, v13
  s_cmp_lg_u64 vcc, 0
  s_cbranch_scc1 xr_43
  buffer_load_dwordx4 v[240:243], v25, s[40:43], s69 offen offset:3072 sc1
  buffer_load_dwordx4 v[244:247], v25, s[40:43], s71 offen offset:3072 sc1
  buffer_load_dwordx4 v[248:251], v25, s[40:43], s73 offen offset:3072 sc1
  buffer_load_dwordx4 v[252:255], v25, s[40:43], s75 offen offset:3072 sc1
  s_waitcnt vmcnt(0)
  s_branch xd_44
xr_46:
  s_sub_u32 s48, s48, 1
  s_cbranch_scc1 L_end
  buffer_load_dwordx4 v[240:243], v25, s[40:43], s69 offen offset:3072 sc1
  buffer_load_dwordx4 v[244:247], v25, s[40:43], s71 offen offset:3072 sc1
  s_waitcnt vmcnt(0)
  v_xor_b32 v240, v240, v14
  v_xor_b32 v241, v241, v15
  v_xor_b32 v244, v244, v14
  v_xor_b32 v245, v245, v15
  v_or3_b32 v13, v240, v241, v244
  v_bitop3_b32 v13, v13, v245, s25 bitop3:0xa8
  v_cmp_ne_u32 vcc, 0, v13
  s_cmp_lg_u64 vcc, 0
  s_cbranch_scc1 xr_46
  buffer_load_dwordx4 v[248:251], v25, s[40:43], s73 offen offset:3072 sc1
  buffer_load_dwordx4 v[252:255], v25, s[40:43], s75 offen offset:3072 sc1
  s_waitcnt vmcnt(0)
  s_branch xd_47
xr_49:
  s_sub_u32 s48, s48, 1
  s_cbranch_scc1 L_end
  buffer_load_dwordx4 v[248:251], v25, s[40:43], s73 offen offset:3072 sc1
  buffer_load_dwordx4 v[252:255], v25, s[40:43], s75 offen offset:3072 sc1
  s_waitcnt vmcnt(0)
  v_xor_b32 v248, v248, v14
  v_xor_b32 v249, v249, v15
  v_xor_b32 v252, v252, v14
  v_xor_b32 v253, v253, v15
  v_or3_b32 v13, v248, v249, v252
  v_bitop3_b32 v13, v13, v253, s25 bitop3:0xa8
  v_cmp_ne_u32 vcc, 0, v13
  s_cmp_lg_u64 vcc, 0
  s_cbranch_scc1 xr_49
  s_waitcnt vmcnt(0)
  s_branch xd_50
ar_51:
  s_sub_u32 s48, s48, 1
  s_cbranch_scc1 L_end
  buffer_load_dwordx4 v[128:131], v1, s[40:43], s76 offen offset:0 sc1
  buffer_load_dwordx4 v[132:135], v21, s[40:43], s76 offen offset:0 sc1
  s_waitcnt vmcnt(0)
  v_xor_b32 v128, v128, v20
  v_xor_b32 v129, v129, v23
  v_xor_b32 v132, v132, v20
  v_xor_b32 v133, v133, v23
  v_or3_b32 v25, v128, v129, v132
  v_bitop3_b32 v25, v25, v133, s25 bitop3:0xa8
  v_cmp_ne_u32 vcc, 0, v25
  s_cmp_lg_u64 vcc, 0
  s_cbranch_scc1 ar_51
  s_branch ad_52
ar_53:
  s_sub_u32 s48, s48, 1
  s_cbranch_scc1 L_end
  buffer_load_dwordx4 v[136:139], v1, s[40:43], s78 offen offset:0 sc1
  buffer_load_dwordx4 v[140:143], v21, s[40:43], s78 offen offset:0 sc1
  s_waitcnt vmcnt(0)
  v_xor_b32 v136, v136, v20
  v_xor_b32 v137, v137, v23
  v_xor_b32 v140, v140, v20
  v_xor_b32 v141, v141, v23
  v_or3_b32 v25, v136, v137, v140
  v_bitop3_b32 v25, v25, v141, s25 bitop3:0xa8
  v_cmp_ne_u32 vcc, 0, v25
  s_cmp_lg_u64 vcc, 0
  s_cbranch_scc1 ar_53
  s_branch ad_54
ar_55:
  s_sub_u32 s48, s48, 1
  s_cbranch_scc1 L_end
  buffer_load_dwordx4 v[144:147], v1, s[40:43], s80 offen offset:0 sc1
  buffer_load_dwordx4 v[148:151], v21, s[40:43], s80 offen offset:0 sc1
  s_waitcnt vmcnt(0)
  v_xor_b32 v144, v144, v20
  v_xor_b32 v145, v145, v23
  v_xor_b32 v148, v148, v20
  v_xor_b32 v149, v149, v23
  v_or3_b32 v25, v144, v145, v148
  v_bitop3_b32 v25, v25, v149, s25 bitop3:0xa8
  v_cmp_ne_u32 vcc, 0, v25
  s_cmp_lg_u64 vcc, 0
  s_cbranch_scc1 ar_55
  s_branch ad_56
ar_57:
  s_sub_u32 s48, s48, 1
  s_cbranch_scc1 L_end
  buffer_load_dwordx4 v[152:155], v1, s[40:43], s32 offen offset:0 sc1
  buffer_load_dwordx4 v[156:159], v21, s[40:43], s32 offen offset:0 sc1
  s_waitcnt vmcnt(0)
  v_xor_b32 v152, v152, v20
  v_xor_b32 v153, v153, v23
  v_xor_b32 v156, v156, v20
  v_xor_b32 v157, v157, v23
  v_or3_b32 v25, v152, v153, v156
  v_bitop3_b32 v25, v25, v157, s25 bitop3:0xa8
  v_cmp_ne_u32 vcc, 0, v25
  s_cmp_lg_u64 vcc, 0
  s_cbranch_scc1 ar_57
  s_branch ad_58
ar_59:
  s_sub_u32 s48, s48, 1
  s_cbranch_scc1 L_end
  buffer_load_dwordx4 v[160:163], v1, s[40:43], s76 offen offset:1024 sc1
  buffer_load_dwordx4 v[164:167], v21, s[40:43], s76 offen offset:1024 sc1
  s_waitcnt vmcnt(0)
  v_xor_b32 v160, v160, v20
  v_xor_b32 v161, v161, v23
  v_xor_b32 v164, v164, v20
  v_xor_b32 v165, v165, v23
  v_or3_b32 v25, v160, v161, v164
  v_bitop3_b32 v25, v25, v165, s25 bitop3:0xa8
  v_cmp_ne_u32 vcc, 0, v25
  s_cmp_lg_u64 vcc, 0
  s_cbranch_scc1 ar_59
  s_branch ad_60
ar_61:
  s_sub_u32 s48, s48, 1
  s_cbranch_scc1 L_end
  buffer_load_dwordx4 v[168:171], v1, s[40:43], s78 offen offset:1024 sc1
  buffer_load_dwordx4 v[172:175], v21, s[40:43], s78 offen offset:1024 sc1
  s_waitcnt vmcnt(0)
  v_xor_b32 v168, v168, v20
  v_xor_b32 v169, v169, v23
  v_xor_b32 v172, v172, v20
  v_xor_b32 v173, v173, v23
  v_or3_b32 v25, v168, v169, v172
  v_bitop3_b32 v25, v25, v173, s25 bitop3:0xa8
  v_cmp_ne_u32 vcc, 0, v25
  s_cmp_lg_u64 vcc, 0
  s_cbranch_scc1 ar_61
  s_branch ad_62
ar_63:
  s_sub_u32 s48, s48, 1
  s_cbranch_scc1 L_end
  buffer_load_dwordx4 v[176:179], v1, s[40:43], s80 offen offset:1024 sc1
  buffer_load_dwordx4 v[180:183], v21, s[40:43], s80 offen offset:1024 sc1
  s_waitcnt vmcnt(0)
  v_xor_b32 v176, v176, v20
  v_xor_b32 v177, v177, v23
  v_xor_b32 v180, v180, v20
  v_xor_b32 v181, v181, v23
  v_or3_b32 v25, v176, v177, v180
  v_bitop3_b32 v25, v25, v181, s25 bitop3:0xa8
  v_cmp_ne_u32 vcc, 0, v25
  s_cmp_lg_u64 vcc, 0
  s_cbranch_scc1 ar_63
  s_branch ad_64
ar_65:
  s_sub_u32 s48, s48, 1
  s_cbranch_scc1 L_end
  buffer_load_dwordx4 v[184:187], v1, s[40:43], s32 offen offset:1024 sc1
  buffer_load_dwordx4 v[188:191], v21, s[40:43], s32 offen offset:1024 sc1
  s_waitcnt vmcnt(0)
  v_xor_b32 v184, v184, v20
  v_xor_b32 v185, v185, v23
  v_xor_b32 v188, v188, v20
  v_xor_b32 v189, v189, v23
  v_or3_b32 v25, v184, v185, v188
  v_bitop3_b32 v25, v25, v189, s25 bitop3:0xa8
  v_cmp_ne_u32 vcc, 0, v25
  s_cmp_lg_u64 vcc, 0
  s_cbranch_scc1 ar_65
  s_branch ad_66
ar_67:
  s_sub_u32 s48, s48, 1
  s_cbranch_scc1 L_end
  buffer_load_dwordx4 v[192:195], v1, s[40:43], s76 offen offset:2048 sc1
  buffer_load_dwordx4 v[196:199], v21, s[40:43], s76 offen offset:2048 sc1
  s_waitcnt vmcnt(0)
  v_xor_b32 v192, v192, v20
  v_xor_b32 v193, v193, v23
  v_xor_b32 v196, v196, v20
  v_xor_b32 v197, v197, v23
  v_or3_b32 v25, v192, v193, v196
  v_bitop3_b32 v25, v25, v197, s25 bitop3:0xa8
  v_cmp_ne_u32 vcc, 0, v25
  s_cmp_lg_u64 vcc, 0
  s_cbranch_scc1 ar_67
  s_branch ad_68
ar_69:
  s_sub_u32 s48, s48, 1
  s_cbranch_scc1 L_end
  buffer_load_dwordx4 v[200:203], v1, s[40:43], s78 offen offset:2048 sc1
  buffer_load_dwordx4 v[204:207], v21, s[40:43], s78 offen offset:2048 sc1
  s_waitcnt vmcnt(0)
  v_xor_b32 v200, v200, v20
  v_xor_b32 v201, v201, v23
  v_xor_b32 v204, v204, v20
  v_xor_b32 v205, v205, v23
  v_or3_b32 v25, v200, v201, v204
  v_bitop3_b32 v25, v25, v205, s25 bitop3:0xa8
  v_cmp_ne_u32 vcc, 0, v25
  s_cmp_lg_u64 vcc, 0
  s_cbranch_scc1 ar_69
  s_branch ad_70
ar_71:
  s_sub_u32 s48, s48, 1
  s_cbranch_scc1 L_end
  buffer_load_dwordx4 v[208:211], v1, s[40:43], s80 offen offset:2048 sc1
  buffer_load_dwordx4 v[212:215], v21, s[40:43], s80 offen offset:2048 sc1
  s_waitcnt vmcnt(0)
  v_xor_b32 v208, v208, v20
  v_xor_b32 v209, v209, v23
  v_xor_b32 v212, v212, v20
  v_xor_b32 v213, v213, v23
  v_or3_b32 v25, v208, v209, v212
  v_bitop3_b32 v25, v25, v213, s25 bitop3:0xa8
  v_cmp_ne_u32 vcc, 0, v25
  s_cmp_lg_u64 vcc, 0
  s_cbranch_scc1 ar_71
  s_branch ad_72
ar_73:
  s_sub_u32 s48, s48, 1
  s_cbranch_scc1 L_end
  buffer_load_dwordx4 v[216:219], v1, s[40:43], s32 offen offset:2048 sc1
  buffer_load_dwordx4 v[220:223], v21, s[40:43], s32 offen offset:2048 sc1
  s_waitcnt vmcnt(0)
  v_xor_b32 v216, v216, v20
  v_xor_b32 v217, v217, v23
  v_xor_b32 v220, v220, v20
  v_xor_b32 v221, v221, v23
  v_or3_b32 v25, v216, v217, v220
  v_bitop3_b32 v25, v25, v221, s25 bitop3:0xa8
  v_cmp_ne_u32 vcc, 0, v25
  s_cmp_lg_u64 vcc, 0
  s_cbranch_scc1 ar_73
  s_branch ad_74
retry_76:
  s_sub_u32 s48, s48, 1
  s_cbranch_scc1 L_end
  buffer_load_dword v3, v24, s[40:43], 0 offen sc1
  s_waitcnt vmcnt(0)
  s_branch chk_75
ar_77:
  s_sub_u32 s48, s48, 1
  s_cbranch_scc1 L_end
  buffer_load_dwordx4 v[224:227], v1, s[40:43], s76 offen offset:3072 sc1
  buffer_load_dwordx4 v[228:231], v21, s[40:43], s76 offen offset:3072 sc1
  s_waitcnt vmcnt(0)
  v_xor_b32 v224, v224, v20
  v_xor_b32 v225, v225, v23
  v_xor_b32 v228, v228, v20
  v_xor_b32 v229, v229, v23
  v_or3_b32 v25, v224, v225, v228
  v_bitop3_b32 v25, v25, v229, s25 bitop3:0xa8
  v_cmp_ne_u32 vcc, 0, v25
  s_cmp_lg_u64 vcc, 0
  s_cbranch_scc1 ar_77
  s_branch ad_78
ar_79:
  s_sub_u32 s48, s48, 1
  s_cbranch_scc1 L_end
  buffer_load_dwordx4 v[232:235], v1, s[40:43], s78 offen offset:3072 sc1
  buffer_load_dwordx4 v[236:239], v21, s[40:43], s78 offen offset:3072 sc1
  s_waitcnt vmcnt(0)
  v_xor_b32 v232, v232, v20
  v_xor_b32 v233, v233, v23
  v_xor_b32 v236, v236, v20
  v_xor_b32 v237, v237, v23
  v_or3_b32 v25, v232, v233, v236
  v_bitop3_b32 v25, v25, v237, s25 bitop3:0xa8
  v_cmp_ne_u32 vcc, 0, v25
  s_cmp_lg_u64 vcc, 0
  s_cbranch_scc1 ar_79
  s_branch ad_80
ar_81:
  s_sub_u32 s48, s48, 1
  s_cbranch_scc1 L_end
  buffer_load_dwordx4 v[240:243], v1, s[40:43], s80 offen offset:3072 sc1
  buffer_load_dwordx4 v[244:247], v21, s[40:43], s80 offen offset:3072 sc1
  s_waitcnt vmcnt(0)
  v_xor_b32 v240, v240, v20
  v_xor_b32 v241, v241, v23
  v_xor_b32 v244, v244, v20
  v_xor_b32 v245, v245, v23
  v_or3_b32 v25, v240, v241, v244
  v_bitop3_b32 v25, v25, v245, s25 bitop3:0xa8
  v_cmp_ne_u32 vcc, 0, v25
  s_cmp_lg_u64 vcc, 0
  s_cbranch_scc1 ar_81
  s_branch ad_82
ar_83:
  s_sub_u32 s48, s48, 1
  s_cbranch_scc1 L_end
  buffer_load_dwordx4 v[248:251], v1, s[40:43], s32 offen offset:3072 sc1
  buffer_load_dwordx4 v[252:255], v21, s[40:43], s32 offen offset:3072 sc1
  s_waitcnt vmcnt(0)
  v_xor_b32 v248, v248, v20
  v_xor_b32 v249, v249, v23
  v_xor_b32 v252, v252, v20
  v_xor_b32 v253, v253, v23
  v_or3_b32 v25, v248, v249, v252
  v_bitop3_b32 v25, v25, v253, s25 bitop3:0xa8
  v_cmp_ne_u32 vcc, 0, v25
  s_cmp_lg_u64 vcc, 0
  s_cbranch_scc1 ar_83
  s_branch ad_84
ar_85:
  s_sub_u32 s48, s48, 1
  s_cbranch_scc1 L_end
  buffer_load_dwordx4 v[128:131], v1, s[40:43], s77 offen offset:0 sc1
  buffer_load_dwordx4 v[132:135], v21, s[40:43], s77 offen offset:0 sc1
  s_waitcnt vmcnt(0)
  v_xor_b32 v128, v128, v20
  v_xor_b32 v129, v129, v23
  v_xor_b32 v132, v132, v20
  v_xor_b32 v133, v133, v23
  v_or3_b32 v25, v128, v129, v132
  v_bitop3_b32 v25, v25, v133, s25 bitop3:0xa8
  v_cmp_ne_u32 vcc, 0, v25
  s_cmp_lg_u64 vcc, 0
  s_cbranch_scc1 ar_85
  s_branch ad_86
ar_87:
  s_sub_u32 s48, s48, 1
  s_cbranch_scc1 L_end
  buffer_load_dwordx4 v[136:139], v1, s[40:43], s79 offen offset:0 sc1
  buffer_load_dwordx4 v[140:143], v21, s[40:43], s79 offen offset:0 sc1
  s_waitcnt vmcnt(0)
  v_xor_b32 v136, v136, v20
  v_xor_b32 v137, v137, v23
  v_xor_b32 v140, v140, v20
  v_xor_b32 v141, v141, v23
  v_or3_b32 v25, v136, v137, v140
  v_bitop3_b32 v25, v25, v141, s25 bitop3:0xa8
  v_cmp_ne_u32 vcc, 0, v25
  s_cmp_lg_u64 vcc, 0
  s_cbranch_scc1 ar_87
  s_branch ad_88
ar_89:
  s_sub_u32 s48, s48, 1
  s_cbranch_scc1 L_end
  buffer_load_dwordx4 v[144:147], v1, s[40:43], s81 offen offset:0 sc1
  buffer_load_dwordx4 v[148:151], v21, s[40:43], s81 offen offset:0 sc1
  s_waitcnt vmcnt(0)
  v_xor_b32 v144, v144, v20
  v_xor_b32 v145, v145, v23
  v_xor_b32 v148, v148, v20
  v_xor_b32 v149, v149, v23
  v_or3_b32 v25, v144, v145, v148
  v_bitop3_b32 v25, v25, v149, s25 bitop3:0xa8
  v_cmp_ne_u32 vcc, 0, v25
  s_cmp_lg_u64 vcc, 0
  s_cbranch_scc1 ar_89
  s_branch ad_90
ar_91:
  s_sub_u32 s48, s48, 1
  s_cbranch_scc1 L_end
  buffer_load_dwordx4 v[152:155], v1, s[40:43], s33 offen offset:0 sc1
  buffer_load_dwordx4 v[156:159], v21, s[40:43], s33 offen offset:0 sc1
  s_waitcnt vmcnt(0)
  v_xor_b32 v152, v152, v20
  v_xor_b32 v153, v153, v23
  v_xor_b32 v156, v156, v20
  v_xor_b32 v157, v157, v23
  v_or3_b32 v25, v152, v153, v156
  v_bitop3_b32 v25, v25, v157, s25 bitop3:0xa8
  v_cmp_ne_u32 vcc, 0, v25
  s_cmp_lg_u64 vcc, 0
  s_cbranch_scc1 ar_91
  s_branch ad_92
ar_93:
  s_sub_u32 s48, s48, 1
  s_cbranch_scc1 L_end
  buffer_load_dwordx4 v[160:163], v1, s[40:43], s77 offen offset:1024 sc1
  buffer_load_dwordx4 v[164:167], v21, s[40:43], s77 offen offset:1024 sc1
  s_waitcnt vmcnt(0)
  v_xor_b32 v160, v160, v20
  v_xor_b32 v161, v161, v23
  v_xor_b32 v164, v164, v20
  v_xor_b32 v165, v165, v23
  v_or3_b32 v25, v160, v161, v164
  v_bitop3_b32 v25, v25, v165, s25 bitop3:0xa8
  v_cmp_ne_u32 vcc, 0, v25
  s_cmp_lg_u64 vcc, 0
  s_cbranch_scc1 ar_93
  s_branch ad_94
ar_95:
  s_sub_u32 s48, s48, 1
  s_cbranch_scc1 L_end
  buffer_load_dwordx4 v[168:171], v1, s[40:43], s79 offen offset:1024 sc1
  buffer_load_dwordx4 v[172:175], v21, s[40:43], s79 offen offset:1024 sc1
  s_waitcnt vmcnt(0)
  v_xor_b32 v168, v168, v20
  v_xor_b32 v169, v169, v23
  v_xor_b32 v172, v172, v20
  v_xor_b32 v173, v173, v23
  v_or3_b32 v25, v168, v169, v172
  v_bitop3_b32 v25, v25, v173, s25 bitop3:0xa8
  v_cmp_ne_u32 vcc, 0, v25
  s_cmp_lg_u64 vcc, 0
  s_cbranch_scc1 ar_95
  s_branch ad_96
ar_97:
  s_sub_u32 s48, s48, 1
  s_cbranch_scc1 L_end
  buffer_load_dwordx4 v[176:179], v1, s[40:43], s81 offen offset:1024 sc1
  buffer_load_dwordx4 v[180:183], v21, s[40:43], s81 offen offset:1024 sc1
  s_waitcnt vmcnt(0)
  v_xor_b32 v176, v176, v20
  v_xor_b32 v177, v177, v23
  v_xor_b32 v180, v180, v20
  v_xor_b32 v181, v181, v23
  v_or3_b32 v25, v176, v177, v180
  v_bitop3_b32 v25, v25, v181, s25 bitop3:0xa8
  v_cmp_ne_u32 vcc, 0, v25
  s_cmp_lg_u64 vcc, 0
  s_cbranch_scc1 ar_97
  s_branch ad_98
ar_99:
  s_sub_u32 s48, s48, 1
  s_cbranch_scc1 L_end
  buffer_load_dwordx4 v[184:187], v1, s[40:43], s33 offen offset:1024 sc1
  buffer_load_dwordx4 v[188:191], v21, s[40:43], s33 offen offset:1024 sc1
  s_waitcnt vmcnt(0)
  v_xor_b32 v184, v184, v20
  v_xor_b32 v185, v185, v23
  v_xor_b32 v188, v188, v20
  v_xor_b32 v189, v189, v23
  v_or3_b32 v25, v184, v185, v188
  v_bitop3_b32 v25, v25, v189, s25 bitop3:0xa8
  v_cmp_ne_u32 vcc, 0, v25
  s_cmp_lg_u64 vcc, 0
  s_cbranch_scc1 ar_99
  s_branch ad_100
ar_101:
  s_sub_u32 s48, s48, 1
  s_cbranch_scc1 L_end
  buffer_load_dwordx4 v[192:195], v1, s[40:43], s77 offen offset:2048 sc1
  buffer_load_dwordx4 v[196:199], v1, s[40:43], s79 offen offset:2048 sc1
  s_waitcnt vmcnt(0)
  v_xor_b32 v192, v192, v20
  v_xor_b32 v193, v193, v23
  v_xor_b32 v196, v196, v20
  v_xor_b32 v197, v197, v23
  v_or3_b32 v25, v192, v193, v196
  v_bitop3_b32 v25, v25, v197, s25 bitop3:0xa8
  v_cmp_ne_u32 vcc, 0, v25
  s_cmp_lg_u64 vcc, 0
  s_cbranch_scc1 ar_101
  s_branch ad_102
ar_103:
  s_sub_u32 s48, s48, 1
  s_cbranch_scc1 L_end
  buffer_load_dwordx4 v[200:203], v1, s[40:43], s81 offen offset:2048 sc1
  buffer_load_dwordx4 v[204:207], v1, s[40:43], s33 offen offset:2048 sc1
  s_waitcnt vmcnt(0)
  v_xor_b32 v200, v200, v20
  v_xor_b32 v201, v201, v23
  v_xor_b32 v204, v204, v20
  v_xor_b32 v205, v205, v23
  v_or3_b32 v25, v200, v201, v204
  v_bitop3_b32 v25, v25, v205, s25 bitop3:0xa8
  v_cmp_ne_u32 vcc, 0, v25
  s_cmp_lg_u64 vcc, 0
  s_cbranch_scc1 ar_103
  s_branch ad_104
ar_105:
  s_sub_u32 s48, s48, 1
  s_cbranch_scc1 L_end
  buffer_load_dwordx4 v[208:211], v21, s[40:43], s77 offen offset:2048 sc1
  buffer_load_dwordx4 v[212:215], v21, s[40:43], s79 offen offset:2048 sc1
  s_waitcnt vmcnt(0)
  v_xor_b32 v208, v208, v20
  v_xor_b32 v209, v209, v23
  v_xor_b32 v212, v212, v20
  v_xor_b32 v213, v213, v23
  v_or3_b32 v25, v208, v209, v212
  v_bitop3_b32 v25, v25, v213, s25 bitop3:0xa8
  v_cmp_ne_u32 vcc, 0, v25
  s_cmp_lg_u64 vcc, 0
  s_cbranch_scc1 ar_105
  s_branch ad_106
ar_107:
  s_sub_u32 s48, s48, 1
  s_cbranch_scc1 L_end
  buffer_load_dwordx4 v[216:219], v21, s[40:43], s81 offen offset:2048 sc1
  buffer_load_dwordx4 v[220:223], v21, s[40:43], s33 offen offset:2048 sc1
  s_waitcnt vmcnt(0)
  v_xor_b32 v216, v216, v20
  v_xor_b32 v217, v217, v23
  v_xor_b32 v220, v220, v20
  v_xor_b32 v221, v221, v23
  v_or3_b32 v25, v216, v217, v220
  v_bitop3_b32 v25, v25, v221, s25 bitop3:0xa8
  v_cmp_ne_u32 vcc, 0, v25
  s_cmp_lg_u64 vcc, 0
  s_cbranch_scc1 ar_107
  s_branch ad_108
L_end:
  s_endpgm
.p2align 8
L_tab:
.long 0xd800d800, 0x0, 0x0, 0x2200000, 0xd840d840, 0x200004, 0x2200004, 0x4400220, 0xd880d880, 0x400300, 0x4400008, 0x6600440, 0xd8c0d8c0, 0x600304, 0x660000c, 0x8800660
.long 0xd800d800, 0x800008, 0x8800010, 0xaa00880, 0xd840d840, 0xa0000c, 0xaa00014, 0xcc00aa0, 0xd880d880, 0xc00308, 0xcc00018, 0xee00cc0, 0xd8c0d8c0, 0xe0030c, 0xee0001c, 0x11000ee0
.long 0xd800d800, 0x1000010, 0x11000020, 0x1100, 0xd840d840, 0x1200014, 0x13200024, 0x1100, 0xd880d880, 0x1400310, 0x15400028, 0x1320, 0xd8c0d8c0, 0x1600314, 0x1760002c, 0x8801540
.long 0xd800d800, 0x1800018, 0x19800030, 0x8801540, 0xd840d840, 0x1a0001c, 0x1ba00034, 0x1540, 0xd880d880, 0x1c00318, 0x1dc00038, 0x1760, 0xd8c0d8c0, 0x1e0031c, 0x1fe0003c, 0x1980
.long 0xd800d804, 0x2000020, 0x100040, 0x2300010, 0xd840d844, 0x2200024, 0x2300044, 0x4500230, 0xd880d884, 0x2400320, 0x4500048, 0x6700450, 0xd8c0d8c4, 0x2600324, 0x670004c, 0x8900670
.long 0xd800d804, 0x2800028, 0x8900050, 0xab00890, 0xd840d844, 0x2a0002c, 0xab00054, 0xcd00ab0, 0xd880d884, 0x2c00328, 0xcd00058, 0xef00cd0, 0xd8c0d8c4, 0x2e0032c, 0xef0005c, 0x11100ef0
.long 0xd800d804, 0x3000030, 0x11100060, 0x101110, 0xd840d844, 0x3200034, 0x13300064, 0x101110, 0xd880d884, 0x3400330, 0x15500068, 0x101330, 0xd8c0d8c4, 0x3600334, 0x1770006c, 0x8901550
.long 0xd800d804, 0x3800038, 0x19900070, 0x8901550, 0xd840d844, 0x3a0003c, 0x1bb00074, 0x101550, 0xd880d884, 0x3c00338, 0x1dd00078, 0x101770, 0xd8c0d8c4, 0x3e0033c, 0x1ff0007c, 0x101990
.long 0xd800d808, 0x4000000, 0x200080, 0x2400020, 0xd840d848, 0x4200004, 0x2400084, 0x4600240, 0xd880d888, 0x4400300, 0x4600088, 0x6800460, 0xd8c0d8c8, 0x4600304, 0x680008c, 0x8a00680
.long 0xd800d808, 0x4800008, 0x8a00090, 0xac008a0, 0xd840d848, 0x4a0000c, 0xac00094, 0xce00ac0, 0xd880d888, 0x4c00308, 0xce00098, 0xf000ce0, 0xd8c0d8c8, 0x4e0030c, 0xf00009c, 0x11200f00
.long 0xd800d808, 0x5000010, 0x112000a0, 0x201120, 0xd840d848, 0x5200014, 0x134000a4, 0x201120, 0xd880d888, 0x5400310, 0x156000a8, 0x201340, 0xd8c0d8c8, 0x5600314, 0x178000ac, 0x8a01560
.long 0xd800d808, 0x5800018, 0x19a000b0, 0x8a01560, 0xd840d848, 0x5a0001c, 0x1bc000b4, 0x201560, 0xd880d888, 0x5c00318, 0x1de000b8, 0x201780, 0xd8c0d8c8, 0x5e0031c, 0x200000bc, 0x2019a0
.long 0xd800d80c, 0x6000020, 0x3000c0, 0x2500030, 0xd840d84c, 0x6200024, 0x25000c4, 0x4700250, 0xd880d88c, 0x6400320, 0x47000c8, 0x6900470, 0xd8c0d8cc, 0x6600324, 0x69000cc, 0x8b00690
.long 0xd800d80c, 0x6800028, 0x8b000d0, 0xad008b0, 0xd840d84c, 0x6a0002c, 0xad000d4, 0xcf00ad0, 0xd880d88c, 0x6c00328, 0xcf000d8, 0xf100cf0, 0xd8c0d8cc, 0x6e0032c, 0xf1000dc, 0x11300f10
.long 0xd800d80c, 0x7000030, 0x113000e0, 0x301130, 0xd840d84c, 0x7200034, 0x135000e4, 0x301130, 0xd880d88c, 0x7400330, 0x157000e8, 0x301350, 0xd8c0d8cc, 0x7600334, 0x179000ec, 0x8b01570
.long 0xd800d80c, 0x7800038, 0x19b000f0, 0x8b01570, 0xd840d84c, 0x7a0003c, 0x1bd000f4, 0x301570, 0xd880d88c, 0x7c00338, 0x1df000f8, 0x301790, 0xd8c0d8cc, 0x7e0033c, 0x201000fc, 0x3019b0
.long 0xd800d810, 0x8000040, 0x22000100, 0x2200000, 0xd840d850, 0x8200044, 0x24200104, 0x4400220, 0xd880d890, 0x8400340, 0x26400108, 0x6600440, 0xd8c0d8d0, 0x8600344, 0x2860010c, 0x8800660
.long 0xd800d810, 0x8800048, 0x2a800110, 0xaa00880, 0xd840d850, 0x8a0004c, 0x2ca00114, 0xcc00aa0, 0xd880d890, 0x8c00348, 0x2ec00118, 0xee00cc0, 0xd8c0d8d0, 0x8e0034c, 0x30e0011c, 0x11000ee0
.long 0xd800d810, 0x9000050, 0x33000120, 0x1100, 0xd840d850, 0x9200054, 0x35200124, 0x1100, 0xd880d890, 0x9400350, 0x37400128, 0x1320, 0xd8c0d8d0, 0x9600354, 0x3960012c, 0x8801540
.long 0xd800d810, 0x9800058, 0x3b800130, 0x8801540, 0xd840d850, 0x9a0005c, 0x3da00134, 0x1540, 0xd880d890, 0x9c00358, 0x3fc00138, 0x1760, 0xd8c0d8d0, 0x9e0035c, 0x41e0013c, 0x1980
.long 0xd800d814, 0xa000060, 0x22100140, 0x2300010, 0xd840d854, 0xa200064, 0x24300144, 0x4500230, 0xd880d894, 0xa400360, 0x26500148, 0x6700450, 0xd8c0d8d4, 0xa600364, 0x2870014c, 0x8900670
.long 0xd800d814, 0xa800068, 0x2a900150, 0xab00890, 0xd840d854, 0xaa0006c, 0x2cb00154, 0xcd00ab0, 0xd880d894, 0xac00368, 0x2ed00158, 0xef00cd0, 0xd8c0d8d4, 0xae0036c, 0x30f0015c, 0x11100ef0
.long 0xd800d814, 0xb000070, 0x33100160, 0x101110, 0xd840d854, 0xb200074, 0x35300164, 0x101110, 0xd880d894, 0xb400370, 0x37500168, 0x101330, 0xd8c0d8d4, 0xb600374, 0x3970016c, 0x8901550
.long 0xd800d814, 0xb800078, 0x3b900170, 0x8901550, 0xd840d854, 0xba0007c, 0x3db00174, 0x101550, 0xd880d894, 0xbc00378, 0x3fd00178, 0x101770, 0xd8c0d8d4, 0xbe0037c, 0x41f0017c, 0x101990
.long 0xd800d818, 0xc000040, 0x22200180, 0x2400020, 0xd840d858, 0xc200044, 0x24400184, 0x4600240, 0xd880d898, 0xc400340, 0x26600188, 0x6800460, 0xd8c0d8d8, 0xc600344, 0x2880018c, 0x8a00680
.long 0xd800d818, 0xc800048, 0x2aa00190, 0xac008a0, 0xd840d858, 0xca0004c, 0x2cc00194, 0xce00ac0, 0xd880d898, 0xcc00348, 0x2ee00198, 0xf000ce0, 0xd8c0d8d8, 0xce0034c, 0x3100019c, 0x11200f00
.long 0xd800d818, 0xd000050, 0x332001a0, 0x201120, 0xd840d858, 0xd200054, 0x354001a4, 0x201120, 0xd880d898, 0xd400350, 0x376001a8, 0x201340, 0xd8c0d8d8, 0xd600354, 0x398001ac, 0x8a01560
.long 0xd800d818, 0xd800058, 0x3ba001b0, 0x8a01560, 0xd840d858, 0xda0005c, 0x3dc001b4, 0x201560, 0xd880d898, 0xdc00358, 0x3fe001b8, 0x201780, 0xd8c0d8d8, 0xde0035c, 0x420001bc, 0x2019a0
.long 0xd800d81c, 0xe000060, 0x223001c0, 0x2500030, 0xd840d85c, 0xe200064, 0x245001c4, 0x4700250, 0xd880d89c, 0xe400360, 0x267001c8, 0x6900470, 0xd8c0d8dc, 0xe600364, 0x289001cc, 0x8b00690
.long 0xd800d81c, 0xe800068, 0x2ab001d0, 0xad008b0, 0xd840d85c, 0xea0006c, 0x2cd001d4, 0xcf00ad0, 0xd880d89c, 0xec00368, 0x2ef001d8, 0xf100cf0, 0xd8c0d8dc, 0xee0036c, 0x311001dc, 0x11300f10
.long 0xd800d81c, 0xf000070, 0x333001e0, 0x301130, 0xd840d85c, 0xf200074, 0x355001e4, 0x301130, 0xd880d89c, 0xf400370, 0x377001e8, 0x301350, 0xd8c0d8dc, 0xf600374, 0x399001ec, 0x8b01570
.long 0xd800d81c, 0xf800078, 0x3bb001f0, 0x8b01570, 0xd840d85c, 0xfa0007c, 0x3dd001f4, 0x301570, 0xd880d89c, 0xfc00378, 0x3ff001f8, 0x301790, 0xd8c0d8dc, 0xfe0037c, 0x421001fc, 0x3019b0
.long 0xd800d820, 0x10000080, 0x72c072c0, 0x74e072c0, 0xd840d860, 0x10200084, 0x74e072c4, 0x770074e0, 0xd880d8a0, 0x10400380, 0x770072c8, 0x79207700, 0xd8c0d8e0, 0x10600384, 0x792072cc, 0x7b407920
.long 0xd800d820, 0x10800088, 0x7b4072d0, 0x7d607b40, 0xd840d860, 0x10a0008c, 0x7d6072d4, 0x7f807d60, 0xd880d8a0, 0x10c00388, 0x7f8072d8, 0x81a07f80, 0xd8c0d8e0, 0x10e0038c, 0x81a072dc, 0x83c081a0
.long 0xd800d820, 0x11000090, 0x83c072e0, 0x72c083c0, 0xd840d860, 0x11200094, 0x85e072e4, 0x72c083c0, 0xd880d8a0, 0x11400390, 0x880072e8, 0x72c085e0, 0xd8c0d8e0, 0x11600394, 0x8a2072ec, 0x7b408800
.long 0xd800d820, 0x11800098, 0x8c4072f0, 0x7b408800, 0xd840d860, 0x11a0009c, 0x8e6072f4, 0x72c08800, 0xd880d8a0, 0x11c00398, 0x908072f8, 0x72c08a20, 0xd8c0d8e0, 0x11e0039c, 0x92a072fc, 0x72c08c40
.long 0xd800d824, 0x120000a0, 0x72d07300, 0x74f072d0, 0xd840d864, 0x122000a4, 0x74f07304, 0x771074f0, 0xd880d8a4, 0x124003a0, 0x77107308, 0x79307710, 0xd8c0d8e4, 0x126003a4, 0x7930730c, 0x7b507930
.long 0xd800d824, 0x128000a8, 0x7b507310, 0x7d707b50, 0xd840d864, 0x12a000ac, 0x7d707314, 0x7f907d70, 0xd880d8a4, 0x12c003a8, 0x7f907318, 0x81b07f90, 0xd8c0d8e4, 0x12e003ac, 0x81b0731c, 0x83d081b0
.long 0xd800d824, 0x130000b0, 0x83d07320, 0x72d083d0, 0xd840d864, 0x132000b4, 0x85f07324, 0x72d083d0, 0xd880d8a4, 0x134003b0, 0x88107328, 0x72d085f0, 0xd8c0d8e4, 0x136003b4, 0x8a30732c, 0x7b508810
.long 0xd800d824, 0x138000b8, 0x8c507330, 0x7b508810, 0xd840d864, 0x13a000bc, 0x8e707334, 0x72d08810, 0xd880d8a4, 0x13c003b8, 0x90907338, 0x72d08a30, 0xd8c0d8e4, 0x13e003bc, 0x92b0733c, 0x72d08c50
.long 0xd800d828, 0x14000080, 0x72e07340, 0x750072e0, 0xd840d868, 0x14200084, 0x75007344, 0x77207500, 0xd880d8a8, 0x14400380, 0x77207348, 0x79407720, 0xd8c0d8e8, 0x14600384, 0x7940734c, 0x7b607940
.long 0xd800d828, 0x14800088, 0x7b607350, 0x7d807b60, 0xd840d868, 0x14a0008c, 0x7d807354, 0x7fa07d80, 0xd880d8a8, 0x14c00388, 0x7fa07358, 0x81c07fa0, 0xd8c0d8e8, 0x14e0038c, 0x81c0735c, 0x83e081c0
.long 0xd800d828, 0x15000090, 0x83e07360, 0x72e083e0, 0xd840d868, 0x15200094, 0x86007364, 0x72e083e0, 0xd880d8a8, 0x15400390, 0x88207368, 0x72e08600, 0xd8c0d8e8, 0x15600394, 0x8a40736c, 0x7b608820
.long 0xd800d828, 0x15800098, 0x8c607370, 0x7b608820, 0xd840d868, 0x15a0009c, 0x8e807374, 0x72e08820, 0xd880d8a8, 0x15c00398, 0x90a07378, 0x72e08a40, 0xd8c0d8e8, 0x15e0039c, 0x92c0737c, 0x72e08c60
.long 0xd800d82c, 0x160000a0, 0x72f07380, 0x751072f0, 0xd840d86c, 0x162000a4, 0x75107384, 0x77307510, 0xd880d8ac, 0x164003a0, 0x77307388, 0x79507730, 0xd8c0d8ec, 0x166003a4, 0x7950738c, 0x7b707950
.long 0xd800d82c, 0x168000a8, 0x7b707390, 0x7d907b70, 0xd840d86c, 0x16a000ac, 0x7d907394, 0x7fb07d90, 0xd880d8ac, 0x16c003a8, 0x7fb07398, 0x81d07fb0, 0xd8c0d8ec, 0x16e003ac, 0x81d0739c, 0x83f081d0
.long 0xd800d82c, 0x170000b0, 0x83f073a0, 0x72f083f0, 0xd840d86c, 0x172000b4, 0x861073a4, 0x72f083f0, 0xd880d8ac, 0x174003b0, 0x883073a8, 0x72f08610, 0xd8c0d8ec, 0x176003b4, 0x8a5073ac, 0x7b708830
.long 0xd800d82c, 0x178000b8, 0x8c7073b0, 0x7b708830, 0xd840d86c, 0x17a000bc, 0x8e9073b4, 0x72f08830, 0xd880d8ac, 0x17c003b8, 0x90b073b8, 0x72f08a50, 0xd8c0d8ec, 0x17e003bc, 0x92d073bc, 0x72f08c70
.long 0xd800d830, 0x180000c0, 0x94c073c0, 0x74e072c0, 0xd840d870, 0x182000c4, 0x96e073c4, 0x770074e0, 0xd880d8b0, 0x184003c0, 0x990073c8, 0x79207700, 0xd8c0d8f0, 0x186003c4, 0x9b2073cc, 0x7b407920
.long 0xd800d830, 0x188000c8, 0x9d4073d0, 0x7d607b40, 0xd840d870, 0x18a000cc, 0x9f6073d4, 0x7f807d60, 0xd880d8b0, 0x18c003c8, 0xa18073d8, 0x81a07f80, 0xd8c0d8f0, 0x18e003cc, 0xa3a073dc, 0x83c081a0
.long 0xd800d830, 0x190000d0, 0xa5c073e0, 0x72c083c0, 0xd840d870, 0x192000d4, 0xa7e073e4, 0x72c083c0, 0xd880d8b0, 0x194003d0, 0xaa0073e8, 0x72c085e0, 0xd8c0d8f0, 0x196003d4, 0xac2073ec, 0x7b408800
.long 0xd800d830, 0x198000d8, 0xae4073f0, 0x7b408800, 0xd840d870, 0x19a000dc, 0xb06073f4, 0x72c08800, 0xd880d8b0, 0x19c003d8, 0xb28073f8, 0x72c08a20, 0xd8c0d8f0, 0x19e003dc, 0xb4a073fc, 0x72c08c40
.long 0xd800d834, 0x1a0000e0, 0x94d07400, 0x74f072d0, 0xd840d874, 0x1a2000e4, 0x96f07404, 0x771074f0, 0xd880d8b4, 0x1a4003e0, 0x99107408, 0x79307710, 0xd8c0d8f4, 0x1a6003e4, 0x9b30740c, 0x7b507930
.long 0xd800d834, 0x1a8000e8, 0x9d507410, 0x7d707b50, 0xd840d874, 0x1aa000ec, 0x9f707414, 0x7f907d70, 0xd880d8b4, 0x1ac003e8, 0xa1907418, 0x81b07f90, 0xd8c0d8f4, 0x1ae003ec, 0xa3b0741c, 0x83d081b0
.long 0xd800d834, 0x1b0000f0, 0xa5d07420, 0x72d083d0, 0xd840d874, 0x1b2000f4, 0xa7f07424, 0x72d083d0, 0xd880d8b4, 0x1b4003f0, 0xaa107428, 0x72d085f0, 0xd8c0d8f4, 0x1b6003f4, 0xac30742c, 0x7b508810
.long 0xd800d834, 0x1b8000f8, 0xae507430, 0x7b508810, 0xd840d874, 0x1ba000fc, 0xb0707434, 0x72d08810, 0xd880d8b4, 0x1bc003f8, 0xb2907438, 0x72d08a30, 0xd8c0d8f4, 0x1be003fc, 0xb4b0743c, 0x72d08c50
.long 0xd800d838, 0x1c0000c0, 0x94e07440, 0x750072e0, 0xd840d878, 0x1c2000c4, 0x97007444, 0x77207500, 0xd880d8b8, 0x1c4003c0, 0x99207448, 0x79407720, 0xd8c0d8f8, 0x1c6003c4, 0x9b40744c, 0x7b607940
.long 0xd800d838, 0x1c8000c8, 0x9d607450, 0x7d807b60, 0xd840d878, 0x1ca000cc, 0x9f807454, 0x7fa07d80, 0xd880d8b8, 0x1cc003c8, 0xa1a07458, 0x81c07fa0, 0xd8c0d8f8, 0x1ce003cc, 0xa3c0745c, 0x83e081c0
.long 0xd800d838, 0x1d0000d0, 0xa5e07460, 0x72e083e0, 0xd840d878, 0x1d2000d4, 0xa8007464, 0x72e083e0, 0xd880d8b8, 0x1d4003d0, 0xaa207468, 0x72e08600, 0xd8c0d8f8, 0x1d6003d4, 0xac40746c, 0x7b608820
.long 0xd800d838, 0x1d8000d8, 0xae607470, 0x7b608820, 0xd840d878, 0x1da000dc, 0xb0807474, 0x72e08820, 0xd880d8b8, 0x1dc003d8, 0xb2a07478, 0x72e08a40, 0xd8c0d8f8, 0x1de003dc, 0xb4c0747c, 0x72e08c60
.long 0xd800d83c, 0x1e0000e0, 0x94f07480, 0x751072f0, 0xd840d87c, 0x1e2000e4, 0x97107484, 0x77307510, 0xd880d8bc, 0x1e4003e0, 0x99307488, 0x79507730, 0xd8c0d8fc, 0x1e6003e4, 0x9b50748c, 0x7b707950
.long 0xd800d83c, 0x1e8000e8, 0x9d707490, 0x7d907b70, 0xd840d87c, 0x1ea000ec, 0x9f907494, 0x7fb07d90, 0xd880d8bc, 0x1ec003e8, 0xa1b07498, 0x81d07fb0, 0xd8c0d8fc, 0x1ee003ec, 0xa3d0749c, 0x83f081d0
.long 0xd800d83c, 0x1f0000f0, 0xa5f074a0, 0x72f083f0, 0xd840d87c, 0x1f2000f4, 0xa81074a4, 0x72f083f0, 0xd880d8bc, 0x1f4003f0, 0xaa3074a8, 0x72f08610, 0xd8c0d8fc, 0x1f6003f4, 0xac5074ac, 0x7b708830
.long 0xd800d83c, 0x1f8000f8, 0xae7074b0, 0x7b708830, 0xd840d87c, 0x1fa000fc, 0xb09074b4, 0x72f08830, 0xd880d8bc, 0x1fc003f8, 0xb2b074b8, 0x72f08a50, 0xd8c0d8fc, 0x1fe003fc, 0xb4d074bc, 0x72f08c70
.long 0x0, 0xa4400000, 0xd468adc0, 0x8200d468, 0x100004, 0xa4440010, 0xd46caec0, 0x8204d46c, 0x200008, 0xa4480020, 0xd470ae00, 0x8208d470, 0x30000c, 0xa44c0030, 0xd474af00, 0x820cd474
.long 0x8000010, 0xa4500040, 0xd478b000, 0x8210d478, 0x8100014, 0xa4540050, 0xd47cb040, 0x8214d47c, 0x8200018, 0xa4580060, 0xd480b080, 0x8218d480, 0x830001c, 0xa45c0070, 0xd484b0c0, 0x821cd484
.long 0x10000020, 0xa8400080, 0xd488c980, 0x8220d488, 0x10100024, 0xa8440090, 0xd48cc980, 0x8224d48c, 0x10200028, 0xa84800a0, 0xd490c980, 0x8228d490, 0x1030002c, 0xa84c00b0, 0xd494c980, 0x822cd494
.long 0x18000030, 0xa85000c0, 0xd498c980, 0x8230d498, 0x18100034, 0xa85400d0, 0xd49cc980, 0x8234d49c, 0x18200038, 0xa85800e0, 0xd4a0c980, 0x8238d4a0, 0x1830003c, 0xa85c00f0, 0xd4a4c980, 0x823cd4a4
.long 0x20000040, 0xa4c00200, 0xd448adc8, 0x8240d448, 0x20100044, 0xa4c40210, 0xd44caec8, 0x8244d44c, 0x20200048, 0xa4c80220, 0xd450ae08, 0x8248d450, 0x2030004c, 0xa4cc0230, 0xd454af08, 0x824cd454
.long 0x28000050, 0xa4d00240, 0xd458b008, 0x8250d458, 0x28100054, 0xa4d40250, 0xd45cb048, 0x8254d45c, 0x28200058, 0xa4d80260, 0xd460b088, 0x8258d460, 0x2830005c, 0xa4dc0270, 0xd464b0c8, 0x825cd464
.long 0x30000060, 0xa8c00280, 0xd468c980, 0x8260d468, 0x30100064, 0xa8c40290, 0xd46cc980, 0x8264d46c, 0x30200068, 0xa8c802a0, 0xd470c980, 0x8268d470, 0x3030006c, 0xa8cc02b0, 0xd474c980, 0x826cd474
.long 0x38000070, 0xa8d002c0, 0xd478c980, 0x8270d478, 0x38100074, 0xa8d402d0, 0xd47cc980, 0x8274d47c, 0x38200078, 0xa8d802e0, 0xd480c980, 0x8278d480, 0x3830007c, 0xa8dc02f0, 0xd484c980, 0x827cd484
.long 0x40000080, 0xa5400400, 0xd428add0, 0x8280d428, 0x40100084, 0xa5440410, 0xd42caed0, 0x8284d42c, 0x40200088, 0xa5480420, 0xd430ae10, 0x8288d430, 0x4030008c, 0xa54c0430, 0xd434af10, 0x828cd434
.long 0x48000090, 0xa5500440, 0xd438b010, 0x8290d438, 0x48100094, 0xa5540450, 0xd43cb050, 0x8294d43c, 0x48200098, 0xa5580460, 0xd440b090, 0x8298d440, 0x4830009c, 0xa55c0470, 0xd444b0d0, 0x829cd444
.long 0x500000a0, 0xa9400480, 0xd448c980, 0x82a0d448, 0x501000a4, 0xa9440490, 0xd44cc980, 0x82a4d44c, 0x502000a8, 0xa94804a0, 0xd450c980, 0x82a8d450, 0x503000ac, 0xa94c04b0, 0xd454c980, 0x82acd454
.long 0x580000b0, 0xa95004c0, 0xd458c980, 0x82b0d458, 0x581000b4, 0xa95404d0, 0xd45cc980, 0x82b4d45c, 0x582000b8, 0xa95804e0, 0xd460c980, 0x82b8d460, 0x583000bc, 0xa95c04f0, 0xd464c980, 0x82bcd464
.long 0x600000c0, 0xa5c00600, 0xd408add8, 0x82c0d408, 0x601000c4, 0xa5c40610, 0xd40caed8, 0x82c4d40c, 0x602000c8, 0xa5c80620, 0xd410ae18, 0x82c8d410, 0x603000cc, 0xa5cc0630, 0xd414af18, 0x82ccd414
.long 0x680000d0, 0xa5d00640, 0xd418b018, 0x82d0d418, 0x681000d4, 0xa5d40650, 0xd41cb058, 0x82d4d41c, 0x682000d8, 0xa5d80660, 0xd420b098, 0x82d8d420, 0x683000dc, 0xa5dc0670, 0xd424b0d8, 0x82dcd424
.long 0x700000e0, 0xa9c00680, 0xd428c980, 0x82e0d428, 0x701000e4, 0xa9c40690, 0xd42cc980, 0x82e4d42c, 0x702000e8, 0xa9c806a0, 0xd430c980, 0x82e8d430, 0x703000ec, 0xa9cc06b0, 0xd434c980, 0x82ecd434
.long 0x780000f0, 0xa9d006c0, 0xd438c980, 0x82f0d438, 0x781000f4, 0xa9d406d0, 0xd43cc980, 0x82f4d43c, 0x782000f8, 0xa9d806e0, 0xd440c980, 0x82f8d440, 0x783000fc, 0xa9dc06f0, 0xd444c980, 0x82fcd444
.long 0x0, 0xa6400000, 0xd468ade0, 0x8300d568, 0x100004, 0xa6440010, 0xd46caee0, 0x8304d56c, 0x200008, 0xa6480020, 0xd470ae20, 0x8308d570, 0x30000c, 0xa64c0030, 0xd474af20, 0x830cd574
.long 0x8000010, 0xa6500040, 0xd478b020, 0x8310d578, 0x8100014, 0xa6540050, 0xd47cb060, 0x8314d57c, 0x8200018, 0xa6580060, 0xd480b0a0, 0x8318d580, 0x830001c, 0xa65c0070, 0xd484b0e0, 0x831cd584
.long 0x10000020, 0xaa400080, 0xd488c980, 0x8320d588, 0x10100024, 0xaa440090, 0xd48cc980, 0x8324d58c, 0x10200028, 0xaa4800a0, 0xd490c980, 0x8328d590, 0x1030002c, 0xaa4c00b0, 0xd494c980, 0x832cd594
.long 0x18000030, 0xaa5000c0, 0xd498c980, 0x8330d598, 0x18100034, 0xaa5400d0, 0xd49cc980, 0x8334d59c, 0x18200038, 0xaa5800e0, 0xd4a0c980, 0x8338d5a0, 0x1830003c, 0xaa5c00f0, 0xd4a4c980, 0x833cd5a4
.long 0x20000040, 0xa6c00200, 0xd448ade8, 0x8340d548, 0x20100044, 0xa6c40210, 0xd44caee8, 0x8344d54c, 0x20200048, 0xa6c80220, 0xd450ae28, 0x8348d550, 0x2030004c, 0xa6cc0230, 0xd454af28, 0x834cd554
.long 0x28000050, 0xa6d00240, 0xd458b028, 0x8350d558, 0x28100054, 0xa6d40250, 0xd45cb068, 0x8354d55c, 0x28200058, 0xa6d80260, 0xd460b0a8, 0x8358d560, 0x2830005c, 0xa6dc0270, 0xd464b0e8, 0x835cd564
.long 0x30000060, 0xaac00280, 0xd468c980, 0x8360d568, 0x30100064, 0xaac40290, 0xd46cc980, 0x8364d56c, 0x30200068, 0xaac802a0, 0xd470c980, 0x8368d570, 0x3030006c, 0xaacc02b0, 0xd474c980, 0x836cd574
.long 0x38000070, 0xaad002c0, 0xd478c980, 0x8370d578, 0x38100074, 0xaad402d0, 0xd47cc980, 0x8374d57c, 0x38200078, 0xaad802e0, 0xd480c980, 0x8378d580, 0x3830007c, 0xaadc02f0, 0xd484c980, 0x837cd584
.long 0x40000080, 0xa7400400, 0xd428adf0, 0x8380d528, 0x40100084, 0xa7440410, 0xd42caef0, 0x8384d52c, 0x40200088, 0xa7480420, 0xd430ae30, 0x8388d530, 0x4030008c, 0xa74c0430, 0xd434af30, 0x838cd534
.long 0x48000090, 0xa7500440, 0xd438b030, 0x8390d538, 0x48100094, 0xa7540450, 0xd43cb070, 0x8394d53c, 0x48200098, 0xa7580460, 0xd440b0b0, 0x8398d540, 0x4830009c, 0xa75c0470, 0xd444b0f0, 0x839cd544
.long 0x500000a0, 0xab400480, 0xd448c980, 0x83a0d548, 0x501000a4, 0xab440490, 0xd44cc980, 0x83a4d54c, 0x502000a8, 0xab4804a0, 0xd450c980, 0x83a8d550, 0x503000ac, 0xab4c04b0, 0xd454c980, 0x83acd554
.long 0x580000b0, 0xab5004c0, 0xd458c980, 0x83b0d558, 0x581000b4, 0xab5404d0, 0xd45cc980, 0x83b4d55c, 0x582000b8, 0xab5804e0, 0xd460c980, 0x83b8d560, 0x583000bc, 0xab5c04f0, 0xd464c980, 0x83bcd564
.long 0x600000c0, 0xa7c00600, 0xd408adf8, 0x83c0d508, 0x601000c4, 0xa7c40610, 0xd40caef8, 0x83c4d50c, 0x602000c8, 0xa7c80620, 0xd410ae38, 0x83c8d510, 0x603000cc, 0xa7cc0630, 0xd414af38, 0x83ccd514
.long 0x680000d0, 0xa7d00640, 0xd418b038, 0x83d0d518, 0x681000d4, 0xa7d40650, 0xd41cb078, 0x83d4d51c, 0x682000d8, 0xa7d80660, 0xd420b0b8, 0x83d8d520, 0x683000dc, 0xa7dc0670, 0xd424b0f8, 0x83dcd524
.long 0x700000e0, 0xabc00680, 0xd428a89c, 0x83e0d528, 0x701000e4, 0xabc40690, 0xd42ca8a0, 0x83e4d52c, 0x702000e8, 0xabc806a0, 0xd430a8a4, 0x83e8d530, 0x703000ec, 0xabcc06b0, 0xd434a968, 0x83ecd534
.long 0x780000f0, 0xabd006c0, 0xd438a96c, 0x83f0d538, 0x781000f4, 0xabd406d0, 0xd43cc980, 0x83f4d53c, 0x782000f8, 0xabd806e0, 0xd440c980, 0x83f8d540, 0x783000fc, 0xabdc06f0, 0xd444c980, 0x83fcd544
.long 0x0, 0xb5000000, 0xd468be80, 0x8400d468, 0x100004, 0xb5040010, 0xd46cbf80, 0x8404d46c, 0x200008, 0xb5080020, 0xd470bec0, 0x8408d470, 0x30000c, 0xb50c0030, 0xd474bfc0, 0x840cd474
.long 0x8000010, 0xb5100040, 0xd478c0c0, 0x8410d478, 0x8100014, 0xb5140050, 0xd47cc100, 0x8414d47c, 0x8200018, 0xb5180060, 0xd480c140, 0x8418d480, 0x830001c, 0xb51c0070, 0xd484c180, 0x841cd484
.long 0x10000020, 0xb9000080, 0xd488c980, 0x8420d488, 0x10100024, 0xb9040090, 0xd48cc980, 0x8424d48c, 0x10200028, 0xb90800a0, 0xd490c980, 0x8428d490, 0x1030002c, 0xb90c00b0, 0xd494c980, 0x842cd494
.long 0x18000030, 0xb91000c0, 0xd498c980, 0x8430d498, 0x18100034, 0xb91400d0, 0xd49cc980, 0x8434d49c, 0x18200038, 0xb91800e0, 0xd4a0c980, 0x8438d4a0, 0x1830003c, 0xb91c00f0, 0xd4a4c980, 0x843cd4a4
.long 0x20000040, 0xb5800200, 0xd448be88, 0x8440d448, 0x20100044, 0xb5840210, 0xd44cbf88, 0x8444d44c, 0x20200048, 0xb5880220, 0xd450bec8, 0x8448d450, 0x2030004c, 0xb58c0230, 0xd454bfc8, 0x844cd454
.long 0x28000050, 0xb5900240, 0xd458c0c8, 0x8450d458, 0x28100054, 0xb5940250, 0xd45cc108, 0x8454d45c, 0x28200058, 0xb5980260, 0xd460c148, 0x8458d460, 0x2830005c, 0xb59c0270, 0xd464c188, 0x845cd464
.long 0x30000060, 0xb9800280, 0xd468c980, 0x8460d468, 0x30100064, 0xb9840290, 0xd46cc980, 0x8464d46c, 0x30200068, 0xb98802a0, 0xd470c980, 0x8468d470, 0x3030006c, 0xb98c02b0, 0xd474c980, 0x846cd474
.long 0x38000070, 0xb99002c0, 0xd478c980, 0x8470d478, 0x38100074, 0xb99402d0, 0xd47cc980, 0x8474d47c, 0x38200078, 0xb99802e0, 0xd480c980, 0x8478d480, 0x3830007c, 0xb99c02f0, 0xd484c980, 0x847cd484
.long 0x40000080, 0xb6000400, 0xd428be90, 0x8480d428, 0x40100084, 0xb6040410, 0xd42cbf90, 0x8484d42c, 0x40200088, 0xb6080420, 0xd430bed0, 0x8488d430, 0x4030008c, 0xb60c0430, 0xd434bfd0, 0x848cd434
.long 0x48000090, 0xb6100440, 0xd438c0d0, 0x8490d438, 0x48100094, 0xb6140450, 0xd43cc110, 0x8494d43c, 0x48200098, 0xb6180460, 0xd440c150, 0x8498d440, 0x4830009c, 0xb61c0470, 0xd444c190, 0x849cd444
.long 0x500000a0, 0xba000480, 0xd448c980, 0x84a0d448, 0x501000a4, 0xba040490, 0xd44cc980, 0x84a4d44c, 0x502000a8, 0xba0804a0, 0xd450c980, 0x84a8d450, 0x503000ac, 0xba0c04b0, 0xd454c980, 0x84acd454
.long 0x580000b0, 0xba1004c0, 0xd458c980, 0x84b0d458, 0x581000b4, 0xba1404d0, 0xd45cc980, 0x84b4d45c, 0x582000b8, 0xba1804e0, 0xd460c980, 0x84b8d460, 0x583000bc, 0xba1c04f0, 0xd464c980, 0x84bcd464
.long 0x600000c0, 0xb6800600, 0xd408be98, 0x84c0d408, 0x601000c4, 0xb6840610, 0xd40cbf98, 0x84c4d40c, 0x602000c8, 0xb6880620, 0xd410bed8, 0x84c8d410, 0x603000cc, 0xb68c0630, 0xd414bfd8, 0x84ccd414
.long 0x680000d0, 0xb6900640, 0xd418c0d8, 0x84d0d418, 0x681000d4, 0xb6940650, 0xd41cc118, 0x84d4d41c, 0x682000d8, 0xb6980660, 0xd420c158, 0x84d8d420, 0x683000dc, 0xb69c0670, 0xd424c198, 0x84dcd424
.long 0x700000e0, 0xba800680, 0xd428c980, 0x84e0d428, 0x701000e4, 0xba840690, 0xd42cc980, 0x84e4d42c, 0x702000e8, 0xba8806a0, 0xd430c980, 0x84e8d430, 0x703000ec, 0xba8c06b0, 0xd434c980, 0x84ecd434
.long 0x780000f0, 0xba9006c0, 0xd438c980, 0x84f0d438, 0x781000f4, 0xba9406d0, 0xd43cc980, 0x84f4d43c, 0x782000f8, 0xba9806e0, 0xd440c980, 0x84f8d440, 0x783000fc, 0xba9c06f0, 0xd444c980, 0x84fcd444
.long 0x0, 0xb7000000, 0xd468bea0, 0x8500d568, 0x100004, 0xb7040010, 0xd46cbfa0, 0x8504d56c, 0x200008, 0xb7080020, 0xd470bee0, 0x8508d570, 0x30000c, 0xb70c0030, 0xd474bfe0, 0x850cd574
.long 0x8000010, 0xb7100040, 0xd478c0e0, 0x8510d578, 0x8100014, 0xb7140050, 0xd47cc120, 0x8514d57c, 0x8200018, 0xb7180060, 0xd480c160, 0x8518d580, 0x830001c, 0xb71c0070, 0xd484c1a0, 0x851cd584
.long 0x10000020, 0xbb000080, 0xd488c980, 0x8520d588, 0x10100024, 0xbb040090, 0xd48cc980, 0x8524d58c, 0x10200028, 0xbb0800a0, 0xd490c980, 0x8528d590, 0x1030002c, 0xbb0c00b0, 0xd494c980, 0x852cd594
.long 0x18000030, 0xbb1000c0, 0xd498c980, 0x8530d598, 0x18100034, 0xbb1400d0, 0xd49cc980, 0x8534d59c, 0x18200038, 0xbb1800e0, 0xd4a0c980, 0x8538d5a0, 0x1830003c, 0xbb1c00f0, 0xd4a4c980, 0x853cd5a4
.long 0x20000040, 0xb7800200, 0xd448bea8, 0x8540d548, 0x20100044, 0xb7840210, 0xd44cbfa8, 0x8544d54c, 0x20200048, 0xb7880220, 0xd450bee8, 0x8548d550, 0x2030004c, 0xb78c0230, 0xd454bfe8, 0x854cd554
.long 0x28000050, 0xb7900240, 0xd458c0e8, 0x8550d558, 0x28100054, 0xb7940250, 0xd45cc128, 0x8554d55c, 0x28200058, 0xb7980260, 0xd460c168, 0x8558d560, 0x2830005c, 0xb79c0270, 0xd464c1a8, 0x855cd564
.long 0x30000060, 0xbb800280, 0xd468c980, 0x8560d568, 0x30100064, 0xbb840290, 0xd46cc980, 0x8564d56c, 0x30200068, 0xbb8802a0, 0xd470c980, 0x8568d570, 0x3030006c, 0xbb8c02b0, 0xd474c980, 0x856cd574
.long 0x38000070, 0xbb9002c0, 0xd478c980, 0x8570d578, 0x38100074, 0xbb9402d0, 0xd47cc980, 0x8574d57c, 0x38200078, 0xbb9802e0, 0xd480c980, 0x8578d580, 0x3830007c, 0xbb9c02f0, 0xd484c980, 0x857cd584
.long 0x40000080, 0xb8000400, 0xd428beb0, 0x8580d528, 0x40100084, 0xb8040410, 0xd42cbfb0, 0x8584d52c, 0x40200088, 0xb8080420, 0xd430bef0, 0x8588d530, 0x4030008c, 0xb80c0430, 0xd434bff0, 0x858cd534
.long 0x48000090, 0xb8100440, 0xd438c0f0, 0x8590d538, 0x48100094, 0xb8140450, 0xd43cc130, 0x8594d53c, 0x48200098, 0xb8180460, 0xd440c170, 0x8598d540, 0x4830009c, 0xb81c0470, 0xd444c1b0, 0x859cd544
.long 0x500000a0, 0xbc000480, 0xd448c980, 0x85a0d548, 0x501000a4, 0xbc040490, 0xd44cc980, 0x85a4d54c, 0x502000a8, 0xbc0804a0, 0xd450c980, 0x85a8d550, 0x503000ac, 0xbc0c04b0, 0xd454c980, 0x85acd554
.long 0x580000b0, 0xbc1004c0, 0xd458c980, 0x85b0d558, 0x581000b4, 0xbc1404d0, 0xd45cc980, 0x85b4d55c, 0x582000b8, 0xbc1804e0, 0xd460c980, 0x85b8d560, 0x583000bc, 0xbc1c04f0, 0xd464c980, 0x85bcd564
.long 0x600000c0, 0xb8800600, 0xd408beb8, 0x85c0d508, 0x601000c4, 0xb8840610, 0xd40cbfb8, 0x85c4d50c, 0x602000c8, 0xb8880620, 0xd410bef8, 0x85c8d510, 0x603000cc, 0xb88c0630, 0xd414bff8, 0x85ccd514
.long 0x680000d0, 0xb8900640, 0xd418c0f8, 0x85d0d518, 0x681000d4, 0xb8940650, 0xd41cc138, 0x85d4d51c, 0x682000d8, 0xb8980660, 0xd420c178, 0x85d8d520, 0x683000dc, 0xb89c0670, 0xd424c1b8, 0x85dcd524
.long 0x700000e0, 0xbc800680, 0xd428b95c, 0x85e0d528, 0x701000e4, 0xbc840690, 0xd42cb960, 0x85e4d52c, 0x702000e8, 0xbc8806a0, 0xd430b964, 0x85e8d530, 0x703000ec, 0xbc8c06b0, 0xd434ba28, 0x85ecd534
.long 0x780000f0, 0xbc9006c0, 0xd438ba2c, 0x85f0d538, 0x781000f4, 0xbc9406d0, 0xd43cc980, 0x85f4d53c, 0x782000f8, 0xbc9806e0, 0xd440c980, 0x85f8d540, 0x783000fc, 0xbc9c06f0, 0xd444c980, 0x85fcd544
.long 0xac68a468, 0x81e0adb0, 0x0, 0x8120, 0xac6ca46c, 0x8200adb4, 0x80040, 0x88140, 0xac70a470, 0x8220adb8, 0x100090, 0x108160, 0xac74a474, 0x8240adbc, 0x1800d0, 0x188180
.long 0xac78a478, 0x8260adc0, 0x400120, 0x4081a0, 0xac7ca47c, 0x8280adc4, 0x480160, 0x4881c0, 0xac80a480, 0x82a0adc8, 0x5001b0, 0x5081e0, 0xac84a484, 0x82c0adcc, 0x5801f0, 0x588200
.long 0xac88a488, 0x82e0add0, 0x900200, 0x808220, 0xac8ca48c, 0x8300add4, 0x980240, 0x888240, 0xac90a490, 0x8320add8, 0x800290, 0x908260, 0xac94a494, 0x8340addc, 0x8802d0, 0x988280
.long 0xac98a498, 0x8360ade0, 0xd00320, 0xc082a0, 0xac9ca49c, 0x8380ade4, 0xd80360, 0xc882c0, 0xaca0a4a0, 0x83a0ade8, 0xc003b0, 0xd082e0, 0xaca4a4a4, 0x83c0adec, 0xc803f0, 0xd88300
.long 0xac48a448, 0x81f0ada0, 0x1200010, 0x208130, 0xac4ca44c, 0x8210ada4, 0x1280050, 0x288150, 0xac50a450, 0x8230ada8, 0x1300080, 0x308170, 0xac54a454, 0x8250adac, 0x13800c0, 0x388190
.long 0xac58a458, 0x8270adb0, 0x1600130, 0x6081b0, 0xac5ca45c, 0x8290adb4, 0x1680170, 0x6881d0, 0xac60a460, 0x82b0adb8, 0x17001a0, 0x7081f0, 0xac64a464, 0x82d0adbc, 0x17801e0, 0x788210
.long 0xac68a468, 0x82f0adc0, 0x1b00210, 0xa08230, 0xac6ca46c, 0x8310adc4, 0x1b80250, 0xa88250, 0xac70a470, 0x8330adc8, 0x1a00280, 0xb08270, 0xac74a474, 0x8350adcc, 0x1a802c0, 0xb88290
.long 0xac78a478, 0x8370add0, 0x1f00330, 0xe082b0, 0xac7ca47c, 0x8390add4, 0x1f80370, 0xe882d0, 0xac80a480, 0x83b0add8, 0x1e003a0, 0xf082f0, 0xac84a484, 0x83d0addc, 0x1e803e0, 0xf88310
.long 0xac28a428, 0x8200ad90, 0x2000020, 0x1008140, 0xac2ca42c, 0x8220ad94, 0x2080060, 0x1088160, 0xac30a430, 0x8240ad98, 0x21000b0, 0x1108180, 0xac34a434, 0x8260ad9c, 0x21800f0, 0x11881a0
.long 0xac38a438, 0x8280ada0, 0x2400100, 0x14081c0, 0xac3ca43c, 0x82a0ada4, 0x2480140, 0x14881e0, 0xac40a440, 0x82c0ada8, 0x2500190, 0x1508200, 0xac44a444, 0x82e0adac, 0x25801d0, 0x1588220
.long 0xac48a448, 0x8300adb0, 0x2900220, 0x1808240, 0xac4ca44c, 0x8320adb4, 0x2980260, 0x1888260, 0xac50a450, 0x8340adb8, 0x28002b0, 0x1908280, 0xac54a454, 0x8360adbc, 0x28802f0, 0x19882a0
.long 0xac58a458, 0x8380adc0, 0x2d00300, 0x1c082c0, 0xac5ca45c, 0x83a0adc4, 0x2d80340, 0x1c882e0, 0xac60a460, 0x83c0adc8, 0x2c00390, 0x1d08300, 0xac64a464, 0x83e0adcc, 0x2c803d0, 0x1d88320
.long 0xac08a408, 0x8210ad80, 0x3200030, 0x1208150, 0xac0ca40c, 0x8230ad84, 0x3280070, 0x1288170, 0xac10a410, 0x8250ad88, 0x33000a0, 0x1308190, 0xac14a414, 0x8270ad8c, 0x33800e0, 0x13881b0
.long 0xac18a418, 0x8290ad90, 0x3600110, 0x16081d0, 0xac1ca41c, 0x82b0ad94, 0x3680150, 0x16881f0, 0xac20a420, 0x82d0ad98, 0x3700180, 0x1708210, 0xac24a424, 0x82f0ad9c, 0x37801c0, 0x1788230
.long 0xac28a428, 0x8310ada0, 0x3b00230, 0x1a08250, 0xac2ca42c, 0x8330ada4, 0x3b80270, 0x1a88270, 0xac30a430, 0x8350ada8, 0x3a002a0, 0x1b08290, 0xac34a434, 0x8370adac, 0x3a802e0, 0x1b882b0
.long 0xac38a438, 0x8390adb0, 0x3f00310, 0x1e082d0, 0xac3ca43c, 0x83b0adb4, 0x3f80350, 0x1e882f0, 0xac40a440, 0x83d0adb8, 0x3e00380, 0x1f08310, 0xac44a444, 0x83f0adbc, 0x3e803c0, 0x1f88330
.long 0xc5e8a668, 0x81d0b150, 0x4002000, 0x20008020, 0xc5eca66c, 0x81f0b154, 0x4082040, 0x20088040, 0xc5f0a670, 0x8210b158, 0x4102090, 0x20108060, 0xc5f4a674, 0x8230b15c, 0x41820d0, 0x20188080
.long 0xc5f8a678, 0x8250b160, 0x4402120, 0x204080a0, 0xc5fca67c, 0x8270b164, 0x4482160, 0x204880c0, 0xc600a680, 0x8290b168, 0x45021b0, 0x205080e0, 0xc604a684, 0x82b0b16c, 0x45821f0, 0x20588100
.long 0xc608a688, 0x82d0b170, 0x4902200, 0x20808120, 0xc60ca68c, 0x82f0b174, 0x4982240, 0x20888140, 0xc610a690, 0x8310b178, 0x4802290, 0x20908160, 0xc614a694, 0x8330b17c, 0x48822d0, 0x20988180
.long 0xc618a698, 0x8350b180, 0x4d02320, 0x20c081a0, 0xc61ca69c, 0x8370b184, 0x4d82360, 0x20c881c0, 0xc620a6a0, 0x8390b188, 0x4c023b0, 0x20d081e0, 0xc624a6a4, 0x83b0b18c, 0x4c823f0, 0x20d88200
.long 0xc5c8a648, 0x81e0b140, 0x5202010, 0x20208030, 0xc5cca64c, 0x8200b144, 0x5282050, 0x20288050, 0xc5d0a650, 0x8220b148, 0x5302080, 0x20308070, 0xc5d4a654, 0x8240b14c, 0x53820c0, 0x20388090
.long 0xc5d8a658, 0x8260b150, 0x5602130, 0x206080b0, 0xc5dca65c, 0x8280b154, 0x5682170, 0x206880d0, 0xc5e0a660, 0x82a0b158, 0x57021a0, 0x207080f0, 0xc5e4a664, 0x82c0b15c, 0x57821e0, 0x20788110
.long 0xc5e8a668, 0x82e0b160, 0x5b02210, 0x20a08130, 0xc5eca66c, 0x8300b164, 0x5b82250, 0x20a88150, 0xc5f0a670, 0x8320b168, 0x5a02280, 0x20b08170, 0xc5f4a674, 0x8340b16c, 0x5a822c0, 0x20b88190
.long 0xc5f8a678, 0x8360b170, 0x5f02330, 0x20e081b0, 0xc5fca67c, 0x8380b174, 0x5f82370, 0x20e881d0, 0xc600a680, 0x83a0b178, 0x5e023a0, 0x20f081f0, 0xc604a684, 0x83c0b17c, 0x5e823e0, 0x20f88210
.long 0xc5a8a628, 0x81f0b130, 0x6002020, 0x21008040, 0xc5aca62c, 0x8210b134, 0x6082060, 0x21088060, 0xc5b0a630, 0x8230b138, 0x61020b0, 0x21108080, 0xc5b4a634, 0x8250b13c, 0x61820f0, 0x211880a0
.long 0xc5b8a638, 0x8270b140, 0x6402100, 0x214080c0, 0xc5bca63c, 0x8290b144, 0x6482140, 0x214880e0, 0xc5c0a640, 0x82b0b148, 0x6502190, 0x21508100, 0xc5c4a644, 0x82d0b14c, 0x65821d0, 0x21588120
.long 0xc5c8a648, 0x82f0b150, 0x6902220, 0x21808140, 0xc5cca64c, 0x8310b154, 0x6982260, 0x21888160, 0xc5d0a650, 0x8330b158, 0x68022b0, 0x21908180, 0xc5d4a654, 0x8350b15c, 0x68822f0, 0x219881a0
.long 0xc5d8a658, 0x8370b160, 0x6d02300, 0x21c081c0, 0xc5dca65c, 0x8390b164, 0x6d82340, 0x21c881e0, 0xc5e0a660, 0x83b0b168, 0x6c02390, 0x21d08200, 0xc5e4a664, 0x83d0b16c, 0x6c823d0, 0x21d88220
.long 0xc588a608, 0x8200b120, 0x7202030, 0x21208050, 0xc58ca60c, 0x8220b124, 0x7282070, 0x21288070, 0xc590a610, 0x8240b128, 0x73020a0, 0x21308090, 0xc594a614, 0x8260b12c, 0x73820e0, 0x213880b0
.long 0xc598a618, 0x8280b130, 0x7602110, 0x216080d0, 0xc59ca61c, 0x82a0b134, 0x7682150, 0x216880f0, 0xc5a0a620, 0x82c0b138, 0x7702180, 0x21708110, 0xc5a4a624, 0x82e0b13c, 0x77821c0, 0x21788130
.long 0xc5a8a628, 0x8300b140, 0x7b02230, 0x21a08150, 0xc5aca62c, 0x8320b144, 0x7b82270, 0x21a88170, 0xc5b0a630, 0x8340b148, 0x7a022a0, 0x21b08190, 0xc5b4a634, 0x8360b14c, 0x7a822e0, 0x21b881b0
.long 0xc5b8a638, 0x8380b150, 0x7f02310, 0x21e081d0, 0xc5bca63c, 0x83a0b154, 0x7f82350, 0x21e881f0, 0xc5c0a640, 0x83c0b158, 0x7e02380, 0x21f08210, 0xc5c4a644, 0x83e0b15c, 0x7e823c0, 0x21f88230
.long 0xbd28b528, 0x93e0be70, 0x8004000, 0x40009320, 0xbd2cb52c, 0x9400be74, 0x8084040, 0x40089340, 0xbd30b530, 0x9420be78, 0x8104090, 0x40109360, 0xbd34b534, 0x9440be7c, 0x81840d0, 0x40189380
.long 0xbd38b538, 0x9460be80, 0x8404120, 0x404093a0, 0xbd3cb53c, 0x9480be84, 0x8484160, 0x404893c0, 0xbd40b540, 0x94a0be88, 0x85041b0, 0x405093e0, 0xbd44b544, 0x94c0be8c, 0x85841f0, 0x40589400
.long 0xbd48b548, 0x94e0be90, 0x8904200, 0x40809420, 0xbd4cb54c, 0x9500be94, 0x8984240, 0x40889440, 0xbd50b550, 0x9520be98, 0x8804290, 0x40909460, 0xbd54b554, 0x9540be9c, 0x88842d0, 0x40989480
.long 0xbd58b558, 0x9560bea0, 0x8d04320, 0x40c094a0, 0xbd5cb55c, 0x9580bea4, 0x8d84360, 0x40c894c0, 0xbd60b560, 0x95a0bea8, 0x8c043b0, 0x40d094e0, 0xbd64b564, 0x95c0beac, 0x8c843f0, 0x40d89500
.long 0xbd08b508, 0x93f0be60, 0x9204010, 0x40209330, 0xbd0cb50c, 0x9410be64, 0x9284050, 0x40289350, 0xbd10b510, 0x9430be68, 0x9304080, 0x40309370, 0xbd14b514, 0x9450be6c, 0x93840c0, 0x40389390
.long 0xbd18b518, 0x9470be70, 0x9604130, 0x406093b0, 0xbd1cb51c, 0x9490be74, 0x9684170, 0x406893d0, 0xbd20b520, 0x94b0be78, 0x97041a0, 0x407093f0, 0xbd24b524, 0x94d0be7c, 0x97841e0, 0x40789410
.long 0xbd28b528, 0x94f0be80, 0x9b04210, 0x40a09430, 0xbd2cb52c, 0x9510be84, 0x9b84250, 0x40a89450, 0xbd30b530, 0x9530be88, 0x9a04280, 0x40b09470, 0xbd34b534, 0x9550be8c, 0x9a842c0, 0x40b89490
.long 0xbd38b538, 0x9570be90, 0x9f04330, 0x40e094b0, 0xbd3cb53c, 0x9590be94, 0x9f84370, 0x40e894d0, 0xbd40b540, 0x95b0be98, 0x9e043a0, 0x40f094f0, 0xbd44b544, 0x95d0be9c, 0x9e843e0, 0x40f89510
.long 0xbce8b4e8, 0x9400be50, 0xa004020, 0x41009340, 0xbcecb4ec, 0x9420be54, 0xa084060, 0x41089360, 0xbcf0b4f0, 0x9440be58, 0xa1040b0, 0x41109380, 0xbcf4b4f4, 0x9460be5c, 0xa1840f0, 0x411893a0
.long 0xbcf8b4f8, 0x9480be60, 0xa404100, 0x414093c0, 0xbcfcb4fc, 0x94a0be64, 0xa484140, 0x414893e0, 0xbd00b500, 0x94c0be68, 0xa504190, 0x41509400, 0xbd04b504, 0x94e0be6c, 0xa5841d0, 0x41589420
.long 0xbd08b508, 0x9500be70, 0xa904220, 0x41809440, 0xbd0cb50c, 0x9520be74, 0xa984260, 0x41889460, 0xbd10b510, 0x9540be78, 0xa8042b0, 0x41909480, 0xbd14b514, 0x9560be7c, 0xa8842f0, 0x419894a0
.long 0xbd18b518, 0x9580be80, 0xad04300, 0x41c094c0, 0xbd1cb51c, 0x95a0be84, 0xad84340, 0x41c894e0, 0xbd20b520, 0x95c0be88, 0xac04390, 0x41d09500, 0xbd24b524, 0x95e0be8c, 0xac843d0, 0x41d89520
.long 0xbcc8b4c8, 0x9410be40, 0xb204030, 0x41209350, 0xbcccb4cc, 0x9430be44, 0xb284070, 0x41289370, 0xbcd0b4d0, 0x9450be48, 0xb3040a0, 0x41309390, 0xbcd4b4d4, 0x9470be4c, 0xb3840e0, 0x413893b0
.long 0xbcd8b4d8, 0x9490be50, 0xb604110, 0x416093d0, 0xbcdcb4dc, 0x94b0be54, 0xb684150, 0x416893f0, 0xbce0b4e0, 0x94d0be58, 0xb704180, 0x41709410, 0xbce4b4e4, 0x94f0be5c, 0xb7841c0, 0x41789430
.long 0xbce8b4e8, 0x9510be60, 0xbb04230, 0x41a09450, 0xbcecb4ec, 0x9530be64, 0xbb84270, 0x41a89470, 0xbcf0b4f0, 0x9550be68, 0xba042a0, 0x41b09490, 0xbcf4b4f4, 0x9570be6c, 0xba842e0, 0x41b894b0
.long 0xbcf8b4f8, 0x9590be70, 0xbf04310, 0x41e094d0, 0xbcfcb4fc, 0x95b0be74, 0xbf84350, 0x41e894f0, 0xbd00b500, 0x95d0be78, 0xbe04380, 0x41f09510, 0xbd04b504, 0x95f0be7c, 0xbe843c0, 0x41f89530
.long 0xc5e8b728, 0x93d0c210, 0xc006000, 0x60009220, 0xc5ecb72c, 0x93f0c214, 0xc086040, 0x60089240, 0xc5f0b730, 0x9410c218, 0xc106090, 0x60109260, 0xc5f4b734, 0x9430c21c, 0xc1860d0, 0x60189280
.long 0xc5f8b738, 0x9450c220, 0xc406120, 0x604092a0, 0xc5fcb73c, 0x9470c224, 0xc486160, 0x604892c0, 0xc600b740, 0x9490c228, 0xc5061b0, 0x605092e0, 0xc604b744, 0x94b0c22c, 0xc5861f0, 0x60589300
.long 0xc608b748, 0x94d0c230, 0xc906200, 0x60809320, 0xc60cb74c, 0x94f0c234, 0xc986240, 0x60889340, 0xc610b750, 0x9510c238, 0xc806290, 0x60909360, 0xc614b754, 0x9530c23c, 0xc8862d0, 0x60989380
.long 0xc618b758, 0x9550c240, 0xcd06320, 0x60c093a0, 0xc61cb75c, 0x9570c244, 0xcd86360, 0x60c893c0, 0xc620b760, 0x9590c248, 0xcc063b0, 0x60d093e0, 0xc624b764, 0x95b0c24c, 0xcc863f0, 0x60d89400
.long 0xc5c8b708, 0x93e0c200, 0xd206010, 0x60209230, 0xc5ccb70c, 0x9400c204, 0xd286050, 0x60289250, 0xc5d0b710, 0x9420c208, 0xd306080, 0x60309270, 0xc5d4b714, 0x9440c20c, 0xd3860c0, 0x60389290
.long 0xc5d8b718, 0x9460c210, 0xd606130, 0x606092b0, 0xc5dcb71c, 0x9480c214, 0xd686170, 0x606892d0, 0xc5e0b720, 0x94a0c218, 0xd7061a0, 0x607092f0, 0xc5e4b724, 0x94c0c21c, 0xd7861e0, 0x60789310
.long 0xc5e8b728, 0x94e0c220, 0xdb06210, 0x60a09330, 0xc5ecb72c, 0x9500c224, 0xdb86250, 0x60a89350, 0xc5f0b730, 0x9520c228, 0xda06280, 0x60b09370, 0xc5f4b734, 0x9540c22c, 0xda862c0, 0x60b89390
.long 0xc5f8b738, 0x9560c230, 0xdf06330, 0x60e093b0, 0xc5fcb73c, 0x9580c234, 0xdf86370, 0x60e893d0, 0xc600b740, 0x95a0c238, 0xde063a0, 0x60f093f0, 0xc604b744, 0x95c0c23c, 0xde863e0, 0x60f89410
.long 0xc5a8b6e8, 0x93f0c1f0, 0xe006020, 0x61009240, 0xc5acb6ec, 0x9410c1f4, 0xe086060, 0x61089260, 0xc5b0b6f0, 0x9430c1f8, 0xe1060b0, 0x61109280, 0xc5b4b6f4, 0x9450c1fc, 0xe1860f0, 0x611892a0
.long 0xc5b8b6f8, 0x9470c200, 0xe406100, 0x614092c0, 0xc5bcb6fc, 0x9490c204, 0xe486140, 0x614892e0, 0xc5c0b700, 0x94b0c208, 0xe506190, 0x61509300, 0xc5c4b704, 0x94d0c20c, 0xe5861d0, 0x61589320
.long 0xc5c8b708, 0x94f0c210, 0xe906220, 0x61809340, 0xc5ccb70c, 0x9510c214, 0xe986260, 0x61889360, 0xc5d0b710, 0x9530c218, 0xe8062b0, 0x61909380, 0xc5d4b714, 0x9550c21c, 0xe8862f0, 0x619893a0
.long 0xc5d8b718, 0x9570c220, 0xed06300, 0x61c093c0, 0xc5dcb71c, 0x9590c224, 0xed86340, 0x61c893e0, 0xc5e0b720, 0x95b0c228, 0xec06390, 0x61d09400, 0xc5e4b724, 0x95d0c22c, 0xec863d0, 0x61d89420
.long 0xc588b6c8, 0x9400c1e0, 0xf206030, 0x61209250, 0xc58cb6cc, 0x9420c1e4, 0xf286070, 0x61289270, 0xc590b6d0, 0x9440c1e8, 0xf3060a0, 0x61309290, 0xc594b6d4, 0x9460c1ec, 0xf3860e0, 0x613892b0
.long 0xc598b6d8, 0x9480c1f0, 0xf606110, 0x616092d0, 0xc59cb6dc, 0x94a0c1f4, 0xf686150, 0x616892f0, 0xc5a0b6e0, 0x94c0c1f8, 0xf706180, 0x61709310, 0xc5a4b6e4, 0x94e0c1fc, 0xf7861c0, 0x61789330
.long 0xc5a8b6e8, 0x9500c200, 0xfb06230, 0x61a09350, 0xc5acb6ec, 0x9520c204, 0xfb86270, 0x61a89370, 0xc5b0b6f0, 0x9540c208, 0xfa062a0, 0x61b09390, 0xc5b4b6f4, 0x9560c20c, 0xfa862e0, 0x61b893b0
.long 0xc5b8b6f8, 0x9580c210, 0xff06310, 0x61e093d0, 0xc5bcb6fc, 0x95a0c214, 0xff86350, 0x61e893f0, 0xc5c0b700, 0x95c0c218, 0xfe06380, 0x61f09410, 0xc5c4b704, 0x95e0c21c, 0xfe863c0, 0x61f89430
.long 0x0, 0x0, 0x0, 0x0, 0x10, 0x10, 0x0, 0x0, 0x20, 0x20, 0x0, 0x0, 0x30, 0x30, 0x0, 0x0
.long 0x2100, 0x1000, 0x0, 0x0, 0x2110, 0x1010, 0x0, 0x0, 0x2120, 0x1020, 0x0, 0x0, 0x2130, 0x1030, 0x0, 0x0
.long 0x4200, 0x2000, 0x0, 0x0, 0x4210, 0x2010, 0x0, 0x0, 0x4220, 0x2020, 0x0, 0x0, 0x4230, 0x2030, 0x0, 0x0
.long 0x6300, 0x3000, 0x0, 0x0, 0x6310, 0x3010, 0x0, 0x0, 0x6320, 0x3020, 0x0, 0x0, 0x6330, 0x3030, 0x0, 0x0
.long 0x8400, 0x4000, 0x0, 0x0, 0x8410, 0x4010, 0x0, 0x0, 0x8420, 0x4020, 0x0, 0x0, 0x8430, 0x4030, 0x3f80, 0x0
.long 0xa500, 0x5000, 0x3f803f80, 0x0, 0xa510, 0x5010, 0x3f803f80, 0x0, 0xa520, 0x5020, 0x3f800000, 0x0, 0xa530, 0x5030, 0x0, 0x0
.long 0xc600, 0x6000, 0x0, 0x0, 0xc610, 0x6010, 0x0, 0x0, 0xc620, 0x6020, 0x0, 0x0, 0xc630, 0x6030, 0x0, 0x0
.long 0xe700, 0x7000, 0x0, 0x0, 0xe710, 0x7010, 0x0, 0x0, 0xe720, 0x7020, 0x0, 0x0, 0xe730, 0x7030, 0x0, 0x0
.long 0x10800, 0x40, 0x0, 0x3f800000, 0x10810, 0x50, 0x0, 0x3f800000, 0x10820, 0x60, 0x0, 0x3f800000, 0x10830, 0x70, 0x0, 0x3f800000
.long 0x12900, 0x1040, 0x0, 0x3f800000, 0x12910, 0x1050, 0x0, 0x3f800000, 0x12920, 0x1060, 0x0, 0x3f800000, 0x12930, 0x1070, 0x0, 0x3f800000
.long 0x14a00, 0x2040, 0x0, 0x3f800000, 0x14a10, 0x2050, 0x0, 0x3f800000, 0x14a20, 0x2060, 0x0, 0x3f800000, 0x14a30, 0x2070, 0x0, 0x3f800000
.long 0x16b00, 0x3040, 0x0, 0x3f800000, 0x16b10, 0x3050, 0x0, 0x3f800000, 0x16b20, 0x3060, 0x0, 0x3f800000, 0x16b30, 0x3070, 0x0, 0x3f800000
.long 0x18c00, 0x4040, 0x0, 0x0, 0x18c10, 0x4050, 0x0, 0x0, 0x18c20, 0x4060, 0x0, 0x0, 0x18c30, 0x4070, 0x0, 0x0
.long 0x1ad00, 0x5040, 0x0, 0x0, 0x1ad10, 0x5050, 0x0, 0x0, 0x1ad20, 0x5060, 0x0, 0x0, 0x1ad30, 0x5070, 0x0, 0x0
.long 0x1ce00, 0x6040, 0x0, 0x0, 0x1ce10, 0x6050, 0x0, 0x0, 0x1ce20, 0x6060, 0x0, 0x0, 0x1ce30, 0x6070, 0x0, 0x0
.long 0x1ef00, 0x7040, 0x0, 0x0, 0x1ef10, 0x7050, 0x0, 0x0, 0x1ef20, 0x7060, 0x0, 0x0, 0x1ef30, 0x7070, 0x0, 0x0
.long 0x21000, 0x70000, 0x0, 0x0, 0x21010, 0x70010, 0x0, 0x0, 0x21020, 0x70020, 0x0, 0x0, 0x21030, 0x70030, 0x0, 0x0
.long 0x23100, 0x71000, 0x0, 0x0, 0x23110, 0x71010, 0x0, 0x0, 0x23120, 0x71020, 0x0, 0x0, 0x23130, 0x71030, 0x0, 0x0
.long 0x25200, 0x72000, 0x0, 0x0, 0x25210, 0x72010, 0x0, 0x0, 0x25220, 0x72020, 0x0, 0x0, 0x25230, 0x72030, 0x0, 0x0
.long 0x27300, 0x73000, 0x0, 0x0, 0x27310, 0x73010, 0x0, 0x0, 0x27320, 0x73020, 0x0, 0x0, 0x27330, 0x73030, 0x0, 0x0
.long 0x29400, 0x74000, 0x0, 0x0, 0x29410, 0x74010, 0x0, 0x0, 0x29420, 0x74020, 0x0, 0x0, 0x29430, 0x74030, 0x0, 0x0
.long 0x2b500, 0x75000, 0x0, 0x0, 0x2b510, 0x75010, 0x0, 0x0, 0x2b520, 0x75020, 0x3f80, 0x0, 0x2b530, 0x75030, 0x3f803f80, 0x0
.long 0x2d600, 0x76000, 0x3f803f80, 0x0, 0x2d610, 0x76010, 0x3f803f80, 0x0, 0x2d620, 0x76020, 0x3f803f80, 0x0, 0x2d630, 0x76030, 0x3f800000, 0x0
.long 0x2f700, 0x77000, 0x0, 0x0, 0x2f710, 0x77010, 0x0, 0x0, 0x2f720, 0x77020, 0x0, 0x0, 0x2f730, 0x77030, 0x0, 0x0
.long 0x31800, 0x70040, 0x0, 0x3f800000, 0x31810, 0x70050, 0x0, 0x3f800000, 0x31820, 0x70060, 0x0, 0x3f800000, 0x31830, 0x70070, 0x0, 0x3f800000
.long 0x33900, 0x71040, 0x0, 0x3f800000, 0x33910, 0x71050, 0x0, 0x3f800000, 0x33920, 0x71060, 0x0, 0x3f800000, 0x33930, 0x71070, 0x0, 0x3f800000
.long 0x35a00, 0x72040, 0x0, 0x3f800000, 0x35a10, 0x72050, 0x0, 0x3f800000, 0x35a20, 0x72060, 0x0, 0x3f800000, 0x35a30, 0x72070, 0x0, 0x3f800000
.long 0x37b00, 0x73040, 0x0, 0x3f800000, 0x37b10, 0x73050, 0x0, 0x3f800000, 0x37b20, 0x73060, 0x0, 0x3f800000, 0x37b30, 0x73070, 0x0, 0x3f800000
.long 0x39c00, 0x74040, 0x0, 0x0, 0x39c10, 0x74050, 0x0, 0x0, 0x39c20, 0x74060, 0x0, 0x0, 0x39c30, 0x74070, 0x0, 0x0
.long 0x3bd00, 0x75040, 0x0, 0x0, 0x3bd10, 0x75050, 0x0, 0x0, 0x3bd20, 0x75060, 0x0, 0x0, 0x3bd30, 0x75070, 0x0, 0x0
.long 0x3de00, 0x76040, 0x0, 0x0, 0x3de10, 0x76050, 0x0, 0x0, 0x3de20, 0x76060, 0x0, 0x0, 0x3de30, 0x76070, 0x0, 0x0
.long 0x3ff00, 0x77040, 0x0, 0x0, 0x3ff10, 0x77050, 0x0, 0x0, 0x3ff20, 0x77060, 0x0, 0x0, 0x3ff30, 0x77070, 0x0, 0x0
.long 0x42000, 0xe0000, 0x0, 0x0, 0x42010, 0xe0010, 0x0, 0x0, 0x42020, 0xe0020, 0x0, 0x0, 0x42030, 0xe0030, 0x0, 0x0
.long 0x44100, 0xe1000, 0x0, 0x0, 0x44110, 0xe1010, 0x0, 0x0, 0x44120, 0xe1020, 0x0, 0x0, 0x44130, 0xe1030, 0x0, 0x0
.long 0x46200, 0xe2000, 0x0, 0x0, 0x46210, 0xe2010, 0x0, 0x0, 0x46220, 0xe2020, 0x0, 0x0, 0x46230, 0xe2030, 0x0, 0x0
.long 0x48300, 0xe3000, 0x0, 0x0, 0x48310, 0xe3010, 0x0, 0x0, 0x48320, 0xe3020, 0x0, 0x0, 0x48330, 0xe3030, 0x0, 0x0
.long 0x4a400, 0xe4000, 0x0, 0x0, 0x4a410, 0xe4010, 0x0, 0x0, 0x4a420, 0xe4020, 0x0, 0x0, 0x4a430, 0xe4030, 0x0, 0x0
.long 0x4c500, 0xe5000, 0x0, 0x0, 0x4c510, 0xe5010, 0x3f80, 0x0, 0x4c520, 0xe5020, 0x3f803f80, 0x0, 0x4c530, 0xe5030, 0x3f803f80, 0x0
.long 0x4e600, 0xe6000, 0x3f803f80, 0x0, 0x4e610, 0xe6010, 0x3f803f80, 0x0, 0x4e620, 0xe6020, 0x3f803f80, 0x0, 0x4e630, 0xe6030, 0x3f803f80, 0x0
.long 0x50700, 0xe7000, 0x3f800000, 0x0, 0x50710, 0xe7010, 0x0, 0x0, 0x50720, 0xe7020, 0x0, 0x0, 0x50730, 0xe7030, 0x0, 0x0
.long 0x52800, 0xe0040, 0x0, 0x3f800000, 0x52810, 0xe0050, 0x0, 0x3f800000, 0x52820, 0xe0060, 0x0, 0x3f800000, 0x52830, 0xe0070, 0x0, 0x3f800000
.long 0x54900, 0xe1040, 0x0, 0x3f800000, 0x54910, 0xe1050, 0x0, 0x3f800000, 0x54920, 0xe1060, 0x0, 0x3f800000, 0x54930, 0xe1070, 0x0, 0x3f800000
.long 0x56a00, 0xe2040, 0x0, 0x3f800000, 0x56a10, 0xe2050, 0x0, 0x3f800000, 0x56a20, 0xe2060, 0x0, 0x3f800000, 0x56a30, 0xe2070, 0x0, 0x3f800000
.long 0x58b00, 0xe3040, 0x0, 0x3f800000, 0x58b10, 0xe3050, 0x0, 0x3f800000, 0x58b20, 0xe3060, 0x0, 0x3f800000, 0x58b30, 0xe3070, 0x0, 0x3f800000
.long 0x5ac00, 0xe4040, 0x0, 0x0, 0x5ac10, 0xe4050, 0x0, 0x0, 0x5ac20, 0xe4060, 0x0, 0x0, 0x5ac30, 0xe4070, 0x0, 0x0
.long 0x5cd00, 0xe5040, 0x0, 0x0, 0x5cd10, 0xe5050, 0x0, 0x0, 0x5cd20, 0xe5060, 0x0, 0x0, 0x5cd30, 0xe5070, 0x0, 0x0
.long 0x5ee00, 0xe6040, 0x0, 0x0, 0x5ee10, 0xe6050, 0x0, 0x0, 0x5ee20, 0xe6060, 0x0, 0x0, 0x5ee30, 0xe6070, 0x0, 0x0
.long 0x60f00, 0xe7040, 0x0, 0x0, 0x60f10, 0xe7050, 0x0, 0x0, 0x60f20, 0xe7060, 0x0, 0x0, 0x60f30, 0xe7070, 0x0, 0x0
.long 0x63000, 0x150000, 0x0, 0x0, 0x63010, 0x150010, 0x0, 0x0, 0x63020, 0x150020, 0x0, 0x0, 0x63030, 0x150030, 0x0, 0x0
.long 0x65100, 0x151000, 0x0, 0x0, 0x65110, 0x151010, 0x0, 0x0, 0x65120, 0x151020, 0x0, 0x0, 0x65130, 0x151030, 0x0, 0x0
.long 0x67200, 0x152000, 0x0, 0x0, 0x67210, 0x152010, 0x0, 0x0, 0x67220, 0x152020, 0x0, 0x0, 0x67230, 0x152030, 0x0, 0x0
.long 0x69300, 0x153000, 0x0, 0x0, 0x69310, 0x153010, 0x0, 0x0, 0x69320, 0x153020, 0x0, 0x0, 0x69330, 0x153030, 0x0, 0x0
.long 0x6b400, 0x154000, 0x0, 0x0, 0x6b410, 0x154010, 0x0, 0x0, 0x6b420, 0x154020, 0x0, 0x0, 0x6b430, 0x154030, 0x0, 0x0
.long 0x6d500, 0x155000, 0x3f80, 0x0, 0x6d510, 0x155010, 0x3f803f80, 0x0, 0x6d520, 0x155020, 0x3f803f80, 0x0, 0x6d530, 0x155030, 0x3f803f80, 0x0
.long 0x6f600, 0x156000, 0x3f803f80, 0x0, 0x6f610, 0x156010, 0x3f803f80, 0x0, 0x6f620, 0x156020, 0x3f803f80, 0x0, 0x6f630, 0x156030, 0x3f803f80, 0x0
.long 0x71700, 0x157000, 0x3f803f80, 0x0, 0x71710, 0x157010, 0x3f800000, 0x0, 0x71720, 0x157020, 0x0, 0x0, 0x71730, 0x157030, 0x0, 0x0
.long 0x73800, 0x150040, 0x0, 0x3f800000, 0x73810, 0x150050, 0x0, 0x3f800000, 0x73820, 0x150060, 0x0, 0x3f800000, 0x73830, 0x150070, 0x0, 0x3f800000
.long 0x75900, 0x151040, 0x0, 0x3f800000, 0x75910, 0x151050, 0x0, 0x3f800000, 0x75920, 0x151060, 0x0, 0x3f800000, 0x75930, 0x151070, 0x0, 0x3f800000
.long 0x77a00, 0x152040, 0x0, 0x3f800000, 0x77a10, 0x152050, 0x0, 0x3f800000, 0x77a20, 0x152060, 0x0, 0x3f800000, 0x77a30, 0x152070, 0x0, 0x3f800000
.long 0x79b00, 0x153040, 0x0, 0x3f800000, 0x79b10, 0x153050, 0x0, 0x3f800000, 0x79b20, 0x153060, 0x0, 0x3f800000, 0x79b30, 0x153070, 0x0, 0x3f800000
.long 0x7bc00, 0x154040, 0x0, 0x0, 0x7bc10, 0x154050, 0x0, 0x0, 0x7bc20, 0x154060, 0x0, 0x0, 0x7bc30, 0x154070, 0x0, 0x0
.long 0x7dd00, 0x155040, 0x0, 0x0, 0x7dd10, 0x155050, 0x0, 0x0, 0x7dd20, 0x155060, 0x0, 0x0, 0x7dd30, 0x155070, 0x0, 0x0
.long 0x7fe00, 0x156040, 0x0, 0x0, 0x7fe10, 0x156050, 0x0, 0x0, 0x7fe20, 0x156060, 0x0, 0x0, 0x7fe30, 0x156070, 0x0, 0x0
.long 0x81f00, 0x157040, 0x0, 0x0, 0x81f10, 0x157050, 0x0, 0x0, 0x81f20, 0x157060, 0x0, 0x0, 0x81f30, 0x157070, 0x0, 0x0
.section .rodata,"a"
.p2align 6
.amdhsa_kernel adaLN_cond__ssm_conv_s4__geglu_ffn__prompt_kernel
  .amdhsa_next_free_vgpr 512
  .amdhsa_next_free_sgpr 102
  .amdhsa_accum_offset 256
  .amdhsa_group_segment_fixed_size 0
  .amdhsa_kernarg_size 144
  .amdhsa_user_sgpr_count 2
  .amdhsa_user_sgpr_kernarg_segment_ptr 1
  .amdhsa_system_sgpr_workgroup_id_x 1
.end_amdhsa_kernel
```
